```python
import torch

def _softmax(x, axis=-1):
    return torch.softmax(x, dim=axis)
def _gelu(x):
    return torch.nn.functional.gelu(x, approximate="tanh")
def _silu(x):
    return torch.nn.functional.silu(x)
def _sigmoid(x):
    return torch.sigmoid(x)
def _layernorm(x, axis=-1, eps=1e-5):
    m = x.mean(dim=axis, keepdim=True)
    v = x.var(dim=axis, keepdim=True, unbiased=False)
    return (x - m) / torch.sqrt(v + eps)
def _scatter_add(tgt, idx, src, axis=0):
    return tgt.clone().index_add_(axis, idx, src)
def _segment_sum(src, seg, n):
    out = torch.zeros((n,) + src.shape[1:], dtype=src.dtype)
    return out.index_add_(0, seg, src)
def _pad(x, pw):
    flat = tuple(v for pair in reversed(pw) for v in pair)
    return torch.nn.functional.pad(x, flat)

kernel_name = 'sequential_preLN__mha_block__mixer_s_mlp__prompt'

def setup_inputs():

    _w = (lambda a: (lambda t: t.to(torch.bfloat16) if t.is_floating_point() else t)(torch.as_tensor(a)))
    def _A_setup():
        B, S, D, H = 1, 2048, 512, 32
        return {
            "x": _w((lambda *s: torch.randn(*s, dtype=torch.bfloat16) * 0.05)(B, S, D)),
            "wqkv": _w((lambda *s: torch.randn(*s, dtype=torch.bfloat16) * 0.05)(D, 3 * D)),
            "wo": _w((lambda *s: torch.randn(*s, dtype=torch.bfloat16) * 0.05)(D, D)),
        }
    _A_in = _A_setup()

    def _B_setup():
        B, S, D, F = 1, 2048, 512, 1376
        return {
            "x":  _w((lambda *s: torch.randn(*s, dtype=torch.bfloat16) * 0.05)(B, S, D)),
            "w1": _w((lambda *s: torch.randn(*s, dtype=torch.bfloat16) * 3.2)(D, D) * (D ** -0.5)),
            "w2": _w((lambda *s: torch.randn(*s, dtype=torch.bfloat16) * 3.2)(D, D) * (D ** -0.5)),
            "w3": _w((lambda *s: torch.randn(*s, dtype=torch.bfloat16) * 3.2)(D, F) * (D ** -0.5)),
            "w4": _w((lambda *s: torch.randn(*s, dtype=torch.bfloat16) * 3.2)(F, D) * (F ** -0.5)),
        }
    _B_in = _B_setup()

    return {
        "A_x": _A_in["x"],
        "A_wqkv": _A_in["wqkv"],
        "A_wo": _A_in["wo"],
        "B_x": _B_in["x"],
        "B_w1": _B_in["w1"],
        "B_w2": _B_in["w2"],
        "B_w3": _B_in["w3"],
        "B_w4": _B_in["w4"],
    }

def reference(A_x, A_wqkv, A_wo, B_x, B_w1, B_w2, B_w3, B_w4):
    def _A_ref(x, wqkv, wo):
        B, S, D = x.shape
        H = 32
        Dh = D // H
        qkv = (lambda x, *d: x.permute(*d))((x @ wqkv).reshape(B, S, 3, H, Dh), 2, 0, 3, 1, 4)
        q, k, v = qkv[0], qkv[1], qkv[2]
        scores = torch.einsum("bhqd,bhkd->bhqk", q, k) * (Dh ** -0.5)
        p = _softmax(scores, axis=-1)
        o = torch.einsum("bhqk,bhkd->bhqd", p, v)
        return (lambda x, *d: x.permute(*d))(o, 0, 2, 1, 3).reshape(B, S, D) @ wo

    def _B_ref(x, w1, w2, w3, w4):
        B, S, D = x.shape
        h = _gelu(_layernorm(x, axis=-1) @ w1)
        c = D // 4
        g0 = _pad(h[:, :, 0*c:1*c], ((0, 0), (1, 0), (0, 0)))[:, :S, :]
        g1 = _pad(h[:, :, 1*c:2*c], ((0, 0), (0, 1), (0, 0)))[:, 1:, :]
        g2 = _pad(h[:, :, 2*c:3*c], ((0, 0), (2, 0), (0, 0)))[:, :S, :]
        g3 = _pad(h[:, :, 3*c:   ], ((0, 0), (0, 2), (0, 0)))[:, 2:, :]
        hs = torch.concatenate([g0, g1, g2, g3], axis=-1) @ w2
        x1 = x + hs
        h2 = _gelu(_layernorm(x1, axis=-1) @ w3) @ w4
        return x1 + h2

    x = A_x
    h = x + _A_ref(_layernorm(x, axis=-1), A_wqkv, A_wo)
    h2 = h + _B_ref(_layernorm(h, axis=-1), B_w1, B_w2, B_w3, B_w4)
    return h2
```

```asm
; @launch grid=(256,1,1) block=(512,1,1) lds=163840
.amdgcn_target "amdgcn-amd-amdhsa--gfx950"
.text
.globl sequential_preLN__mha_block__mixer_s_mlp__prompt_kernel
.p2align 8
.type sequential_preLN__mha_block__mixer_s_mlp__prompt_kernel,@function
.p2align 8
sequential_preLN__mha_block__mixer_s_mlp__prompt_kernel:
    s_cmp_ge_u32 s2, 256
    s_cbranch_scc1 M_done
    s_load_dwordx4 s[4:7], s[0:1], 0
    s_load_dwordx2 s[52:53], s[0:1], 80
    v_lshrrev_b32 v2, 6, v0
    v_and_b32 v1, 63, v0
    v_readfirstlane_b32 s3, v2
    s_lshr_b32 s24, s2, 3
    s_and_b32 s25, s24, 7
    s_lshr_b32 s24, s24, 3
    s_mov_b32 s27, 0
    s_add_u32 s27, s24, s25
    s_mul_i32 s27, s27, 2
    s_and_b32 s26, s2, 6
    s_lshl_b32 s26, s26, 2
    s_add_u32 s36, s26, s25
    s_and_b32 s26, s2, 1
    s_lshl_b32 s26, s26, 2
    s_add_u32 s37, s26, s24
    v_lshrrev_b32 v2, 3, v1
    v_and_b32 v3, 7, v1
    v_lshrrev_b32 v4, 4, v1
    v_lshrrev_b32 v5, 2, v1
    v_and_b32 v5, 4, v5
    v_xor_b32 v5, v3, v5
    v_lshlrev_b32 v5, 4, v5
    s_lshl_b32 s96, s37, 5
    s_add_u32 s96, s96, s36
    s_and_b32 s97, s2, 7
    s_bfe_u32 s98, s2, 0x20003
    s_lshl2_add_u32 s98, s97, s98
    s_sub_u32 s98, s98, 5
    s_lshl_b32 s97, s97, 5
    v_add_u32 v236, s98, v2
    v_med3_i32 v236, v236, 0, 31
    v_lshl_add_u32 v236, v3, 5, v236
    v_add_u32 v235, s97, v1
    v_cmp_gt_u32 vcc, 32, v1
    s_nop 1
    v_cndmask_b32 v236, v236, v235, vcc
    v_writelane_b32 v236, s96, 63
    v_mul_u32_u24 v236, 256, v236
    s_mul_i32 s96, s96, 256
    s_add_u32 s96, s96, 0x940000
    s_mov_b32 s99, 0x940000
    s_cmp_lt_u32 s3, 4
    s_cbranch_scc0 K_cons
    v_xor_b32 v6, v3, v4
    v_lshlrev_b32 v6, 4, v6
    v_lshl_add_u32 v6, v2, 10, v6
    v_xor_b32 v7, 64, v6
    v_add_u32 v7, 7168, v7
    v_mul_u32_u24 v8, 3072, v2
    v_add_u32 v8, v8, v5
    s_lshl_b32 s38, s36, 16
    s_lshl_b32 s24, s3, 14
    s_add_u32 s38, s38, s24
    s_lshl_b32 s39, s37, 7
    s_mul_i32 s24, s3, 49152
    s_add_u32 s39, s39, s24
    s_lshl_b32 s42, s3, 11
    s_mul_i32 s43, s3, 6144
    s_add_u32 s43, s43, 8192
    s_mov_b32 s28, 0
    s_mov_b32 s29, -3
    v_and_b32 v9, 15, v1
    v_lshrrev_b32 v10, 1, v9
    v_xor_b32 v10, v10, v4
    v_lshlrev_b32 v10, 4, v10
    v_lshl_add_u32 v10, v9, 7, v10
    v_add_u32 v10, s42, v10
    v_xor_b32 v11, 64, v10
    v_mov_b32 v12, 0x3f803f80
    v_mov_b32 v16, 0
    v_mov_b32 v20, 0
    v_mov_b32 v13, 0x3f803f80
    v_mov_b32 v17, 0
    v_mov_b32 v21, 0
    v_mov_b32 v14, 0x3f803f80
    v_mov_b32 v18, 0
    v_mov_b32 v22, 0
    v_mov_b32 v15, 0x3f803f80
    v_mov_b32 v19, 0
    v_mov_b32 v23, 0
    s_waitcnt lgkmcnt(0)
    s_mov_b32 s12, s4
    s_mov_b32 s13, s5
    s_mov_b32 s14, 0x200000
    s_mov_b32 s15, 0x00020000
    s_mov_b32 s16, s6
    s_mov_b32 s17, s7
    s_mov_b32 s18, 0x180000
    s_mov_b32 s19, 0x00020000
    s_mov_b32 s8, s52
    s_mov_b32 s9, s53
    s_mov_b32 s10, 0xc00000
    s_mov_b32 s11, 0x00020000
    s_cmp_lg_u32 s3, 0
    s_cbranch_scc1 H_ns
    buffer_load_dword v235, v236, s[8:11], s99 offen sc1
H_ns:
H_issue:
    s_and_b32 s27, s27, 7
    s_lshl_b32 s24, s27, 7
    s_add_u32 s24, s24, s38
    s_mul_i32 s25, s27, 196608
    s_add_u32 s25, s25, s39
    s_add_u32 s26, s25, 24576
    s_add_u32 m0, s28, s42
    s_nop 0
    buffer_load_dwordx4 v6, s[12:15], s24 offen lds
    buffer_load_dwordx4 v7, s[12:15], s24 offen offset:1024 lds
    s_add_u32 m0, s28, s43
    s_nop 0
    buffer_load_dwordx4 v8, s[16:19], s25 offen offset:0 lds
    buffer_load_dwordx4 v8, s[16:19], s25 offen offset:1024 lds
    buffer_load_dwordx4 v8, s[16:19], s25 offen offset:2048 lds
    s_add_u32 m0, m0, 3072
    s_add_u32 s27, s27, 1
    s_add_u32 s28, s28, 0x8000
    s_and_b32 s28, s28, 0x1ffff
    s_cmp_lt_i32 s29, 0
    s_cbranch_scc1 H_is2
H_st:
    s_waitcnt lgkmcnt(0)
    v_mfma_f32_16x16x32_bf16 v[16:19], v[24:27], v[24:27], v[16:19]
    v_mfma_f32_16x16x32_bf16 v[20:23], v[12:15], v[24:27], v[20:23]
    v_mfma_f32_16x16x32_bf16 v[16:19], v[28:31], v[28:31], v[16:19]
    v_mfma_f32_16x16x32_bf16 v[20:23], v[12:15], v[28:31], v[20:23]
    v_add_u32 v10, 0x8000, v10
    v_and_b32 v10, 0x1ffff, v10
    v_xor_b32 v11, 64, v10
    s_cmp_gt_u32 s29, 4
    s_cbranch_scc1 H_late
H_is2:
    buffer_load_dwordx4 v8, s[16:19], s26 offen offset:0 lds
    buffer_load_dwordx4 v8, s[16:19], s26 offen offset:1024 lds
    buffer_load_dwordx4 v8, s[16:19], s26 offen offset:2048 lds
    s_add_u32 s29, s29, 1
    s_cmp_lt_i32 s29, 0
    s_cbranch_scc1 H_issue
    s_waitcnt vmcnt(16)
H_b:
    s_barrier
    ds_read_b128 v[24:27], v10
    ds_read_b128 v[28:31], v11
    s_cmp_lt_u32 s29, 5
    s_cbranch_scc1 H_issue
    s_branch H_st
H_late:
    s_cmp_lg_u32 s29, 5
    s_cbranch_scc1 H_l2
    v_mov_b32 v32, -1
    v_mov_b32 v33, -1
    v_mov_b32 v34, -1
    v_mov_b32 v35, -1
    v_lshlrev_b32 v36, 4, v1
    s_mul_i32 s46, s36, 278528
    s_mul_i32 s47, s37, 10
    s_add_u32 s47, s47, s3
    s_lshl_b32 s47, s47, 10
    s_add_u32 s46, s46, s47
    s_add_u32 s46, s46, 0x20000
    buffer_store_dwordx4 v[32:35], v36, s[8:11], s46 offen sc1
    s_add_u32 s46, s46, 4096
    buffer_store_dwordx4 v[32:35], v36, s[8:11], s46 offen sc1
    s_add_u32 s46, s46, 4096
    s_lshr_b32 s45, s36, 3
    s_lshl_b32 s45, s45, 15
    s_and_b32 s47, s36, 7
    s_lshl_b32 s47, s47, 7
    s_add_u32 s45, s45, s47
    s_lshl_b32 s47, s37, 12
    s_add_u32 s45, s45, s47
    s_add_u32 s45, s45, 0x900000
    s_cmp_eq_u32 s3, 3
    s_cselect_b32 s45, 0x40000000, s45
    v_and_b32 v37, 3, v2
    v_lshlrev_b32 v37, 10, v37
    v_lshl_add_u32 v37, v3, 4, v37
    s_cmp_lt_u32 s3, 2
    s_cselect_b32 s46, s46, s45
    s_cselect_b64 vcc, -1, 0
    v_cndmask_b32 v37, v37, v36, vcc
    buffer_store_dwordx4 v[32:35], v37, s[8:11], s46 offen sc1
H_l2:
    s_add_u32 s29, s29, 1
    s_cmp_eq_u32 s29, 8
    s_cbranch_scc1 H_end
    s_cmp_eq_u32 s29, 7
    s_cbranch_scc1 H_l3
    s_waitcnt vmcnt(11)
    s_branch H_b
H_l3:
    s_waitcnt vmcnt(3)
    s_branch H_b
H_end:
    v_and_b32 v11, 3, v1
    v_cmp_eq_u32 vcc, 1, v11
    s_nop 1
    v_cndmask_b32 v16, v16, v17, vcc
    v_cmp_eq_u32 vcc, 2, v11
    s_nop 1
    v_cndmask_b32 v16, v16, v18, vcc
    v_cmp_eq_u32 vcc, 3, v11
    s_nop 1
    v_cndmask_b32 v16, v16, v19, vcc
    v_mul_f32 v20, 0x3b000000, v20
    v_mul_f32 v16, 0x3b000000, v16
    v_fma_f32 v16, -v20, v20, v16
    v_max_f32 v16, 0, v16
    v_add_f32 v16, 0x3727c5ac, v16
    v_rsq_f32 v16, v16
    s_lshl_b32 s24, s3, 6
    s_add_u32 s24, s24, 155648
    v_lshl_add_u32 v9, v9, 2, s24
    v_mul_f32 v20, v20, v16
    v_sub_f32 v20, 0, v20
    s_mov_b32 s24, 0x00f0000f
    s_mov_b32 s25, 0xf0000f00
    s_mov_b64 exec, s[24:25]
    ds_write2st64_b32 v9, v16, v20 offset0:0 offset1:1
    s_mov_b64 exec, -1
    s_waitcnt lgkmcnt(0)
    s_barrier
    s_branch M_start
K_cons:
    s_and_b32 s38, s3, 1
    s_bfe_u32 s39, s3, 0x10001
    s_and_b32 s43, s3, 3
    v_lshlrev_b32 v9, 4, v1
    v_mov_b32 v16, 0
    v_mov_b32 v17, 0
    v_mov_b32 v18, 0
    v_mov_b32 v19, 0
    v_mov_b32 v20, 0
    v_mov_b32 v21, 0
    v_mov_b32 v22, 0
    v_mov_b32 v23, 0
    v_mov_b32 v24, 0
    v_mov_b32 v25, 0
    v_mov_b32 v26, 0
    v_mov_b32 v27, 0
    v_mov_b32 v28, 0
    v_mov_b32 v29, 0
    v_mov_b32 v30, 0
    v_mov_b32 v31, 0
    v_mov_b32 v32, 0
    v_mov_b32 v33, 0
    v_mov_b32 v34, 0
    v_mov_b32 v35, 0
    v_mov_b32 v36, 0
    v_mov_b32 v37, 0
    v_mov_b32 v38, 0
    v_mov_b32 v39, 0
    v_mov_b32 v40, 0
    v_mov_b32 v41, 0
    v_mov_b32 v42, 0
    v_mov_b32 v43, 0
    v_mov_b32 v44, 0
    v_mov_b32 v45, 0
    v_mov_b32 v46, 0
    v_mov_b32 v47, 0
    v_mov_b32 v48, 0
    v_mov_b32 v49, 0
    v_mov_b32 v50, 0
    v_mov_b32 v51, 0
    v_mov_b32 v52, 0
    v_mov_b32 v53, 0
    v_mov_b32 v54, 0
    v_mov_b32 v55, 0
    v_mov_b32 v56, 0
    v_mov_b32 v57, 0
    v_mov_b32 v58, 0
    v_mov_b32 v59, 0
    v_mov_b32 v60, 0
    v_mov_b32 v61, 0
    v_mov_b32 v62, 0
    v_mov_b32 v63, 0
    v_mov_b32 v64, 0
    v_mov_b32 v65, 0
    v_mov_b32 v66, 0
    v_mov_b32 v67, 0
    v_mov_b32 v68, 0
    v_mov_b32 v69, 0
    v_mov_b32 v70, 0
    v_mov_b32 v71, 0
    v_mov_b32 v72, 0
    v_mov_b32 v73, 0
    v_mov_b32 v74, 0
    v_mov_b32 v75, 0
    v_mov_b32 v112, 0
    v_mov_b32 v113, 0
    v_mov_b32 v114, 0
    v_mov_b32 v115, 0
    v_mov_b32 v116, 0
    v_mov_b32 v117, 0
    v_mov_b32 v118, 0
    v_mov_b32 v119, 0
    v_mov_b32 v120, 0
    v_mov_b32 v121, 0
    v_mov_b32 v122, 0
    v_mov_b32 v123, 0
    v_mov_b32 v124, 0
    v_mov_b32 v125, 0
    v_mov_b32 v126, 0
    v_mov_b32 v127, 0
    v_mov_b32 v128, 0
    v_mov_b32 v129, 0
    v_mov_b32 v130, 0
    v_mov_b32 v131, 0
    v_mov_b32 v132, 0
    v_mov_b32 v133, 0
    v_mov_b32 v134, 0
    v_mov_b32 v135, 0
    v_mov_b32 v136, 0
    v_mov_b32 v137, 0
    v_mov_b32 v138, 0
    v_mov_b32 v139, 0
    v_mov_b32 v140, 0
    v_mov_b32 v141, 0
    v_mov_b32 v142, 0
    v_mov_b32 v143, 0
    v_and_b32 v8, 15, v1
    v_and_b32 v10, 1, v4
    v_cmp_eq_u32 vcc, v8, v10
    v_mov_b32 v8, 0x3f803f80
    s_nop 0
    v_cndmask_b32 v76, 0, v8, vcc
    v_mov_b32 v77, v76
    v_mov_b32 v78, v76
    v_mov_b32 v79, v76
    s_waitcnt lgkmcnt(0)
    s_mov_b32 s12, s4
    s_mov_b32 s13, s5
    s_mov_b32 s14, 0x200000
    s_mov_b32 s15, 0x00020000
    s_mov_b32 s16, s6
    s_mov_b32 s17, s7
    s_mov_b32 s18, 0x180000
    s_mov_b32 s19, 0x00020000
    s_mov_b32 s8, s52
    s_mov_b32 s9, s53
    s_mov_b32 s10, 0xc00000
    s_mov_b32 s11, 0x00020000
    v_and_b32 v3, 31, v1
    v_lshrrev_b32 v4, 5, v1
    v_bfe_u32 v6, v1, 1, 3
    v_xor_b32 v6, v6, v4
    s_lshl_b32 s24, s39, 2
    v_xor_b32 v6, s24, v6
    v_lshlrev_b32 v6, 4, v6
    v_lshl_add_u32 v6, v3, 7, v6
    s_lshl_b32 s24, s39, 12
    v_add_u32 v6, s24, v6
    v_lshrrev_b32 v7, 2, v1
    v_and_b32 v8, 3, v7
    v_and_b32 v10, 2, v7
    v_lshlrev_b32 v10, 5, v10
    s_lshl_b32 s24, s38, 6
    v_xor_b32 v10, s24, v10
    v_and_b32 v7, 4, v7
    v_lshl_add_u32 v10, v7, 3, v10
    v_and_b32 v7, 3, v1
    v_lshl_add_u32 v10, v7, 3, v10
    v_lshl_add_u32 v10, v8, 7, v10
    v_mul_u32_u24 v7, 3072, v4
    v_add_u32 v10, v10, v7
    s_mul_i32 s24, s39, 12288
    s_add_u32 s25, s24, 8192
    v_add_u32 v7, s25, v10
    s_sub_u32 s25, 20480, s24
    v_add_u32 v8, s25, v10
    v_xor_b32 v10, 32, v6
    v_xor_b32 v11, 64, v6
    v_xor_b32 v12, 96, v6
    s_mov_b32 s29, 8
    s_setprio 3
C_loop:
    s_barrier
    v_mfma_f32_32x32x16_bf16 v[16:31], v[116:119], v[112:115], v[16:31]
    ds_read_b128 v[80:83], v6
    ds_read_b64_tr_b16 v[84:85], v7 offset:0
    ds_read_b64_tr_b16 v[86:87], v7 offset:512
    v_mfma_f32_32x32x16_bf16 v[32:47], v[120:123], v[112:115], v[32:47]
    ds_read_b64_tr_b16 v[88:89], v7 offset:1024
    ds_read_b64_tr_b16 v[90:91], v7 offset:1536
    ds_read_b64_tr_b16 v[92:93], v7 offset:2048
    v_mfma_f32_32x32x16_bf16 v[48:63], v[112:115], v[124:127], v[48:63]
    ds_read_b64_tr_b16 v[94:95], v7 offset:2560
    ds_read_b128 v[96:99], v10
    ds_read_b64_tr_b16 v[100:101], v7 offset:6144
    v_mfma_f32_32x32x16_bf16 v[16:31], v[132:135], v[128:131], v[16:31]
    ds_read_b64_tr_b16 v[102:103], v7 offset:6656
    ds_read_b64_tr_b16 v[104:105], v7 offset:7168
    ds_read_b64_tr_b16 v[106:107], v7 offset:7680
    v_mfma_f32_32x32x16_bf16 v[32:47], v[136:139], v[128:131], v[32:47]
    ds_read_b64_tr_b16 v[108:109], v7 offset:8192
    ds_read_b64_tr_b16 v[110:111], v7 offset:8704
    ds_read_b128 v[112:115], v11
    v_mfma_f32_32x32x16_bf16 v[48:63], v[128:131], v[140:143], v[48:63]
    ds_read_b64_tr_b16 v[116:117], v8 offset:0
    ds_read_b64_tr_b16 v[118:119], v8 offset:512
    ds_read_b64_tr_b16 v[120:121], v8 offset:1024
    s_waitcnt lgkmcnt(11)
    v_mfma_f32_32x32x16_bf16 v[16:31], v[84:87], v[80:83], v[16:31]
    v_mfma_f32_16x16x32_bf16 v[64:67], v[76:79], v[84:87], v[64:67]
    ds_read_b64_tr_b16 v[122:123], v8 offset:1536
    ds_read_b64_tr_b16 v[124:125], v8 offset:2048
    ds_read_b64_tr_b16 v[126:127], v8 offset:2560
    v_mfma_f32_32x32x16_bf16 v[32:47], v[88:91], v[80:83], v[32:47]
    v_mfma_f32_16x16x32_bf16 v[68:71], v[76:79], v[88:91], v[68:71]
    ds_read_b128 v[128:131], v12
    ds_read_b64_tr_b16 v[132:133], v8 offset:6144
    ds_read_b64_tr_b16 v[134:135], v8 offset:6656
    ds_read_b64_tr_b16 v[136:137], v8 offset:7168
    v_mfma_f32_32x32x16_bf16 v[48:63], v[80:83], v[92:95], v[48:63]
    v_mfma_f32_16x16x32_bf16 v[72:75], v[76:79], v[92:95], v[72:75]
    ds_read_b64_tr_b16 v[138:139], v8 offset:7680
    ds_read_b64_tr_b16 v[140:141], v8 offset:8192
    ds_read_b64_tr_b16 v[142:143], v8 offset:8704
    s_waitcnt lgkmcnt(14)
    v_mfma_f32_32x32x16_bf16 v[16:31], v[100:103], v[96:99], v[16:31]
    v_mfma_f32_16x16x32_bf16 v[64:67], v[76:79], v[100:103], v[64:67]
    v_add_u32 v6, 0x8000, v6
    v_and_b32 v6, 0x1ffff, v6
    v_xor_b32 v10, 32, v6
    v_mfma_f32_32x32x16_bf16 v[32:47], v[104:107], v[96:99], v[32:47]
    v_mfma_f32_16x16x32_bf16 v[68:71], v[76:79], v[104:107], v[68:71]
    v_add_u32 v7, 0x8000, v7
    v_and_b32 v7, 0x1ffff, v7
    v_xor_b32 v11, 64, v6
    v_mfma_f32_32x32x16_bf16 v[48:63], v[96:99], v[108:111], v[48:63]
    v_mfma_f32_16x16x32_bf16 v[72:75], v[76:79], v[108:111], v[72:75]
    v_add_u32 v8, 0x8000, v8
    v_and_b32 v8, 0x1ffff, v8
    v_xor_b32 v12, 96, v6
    s_sub_u32 s29, s29, 1
    s_cmp_lg_u32 s29, 0
    s_waitcnt lgkmcnt(0)
    s_cbranch_scc1 C_loop
    v_mfma_f32_32x32x16_bf16 v[16:31], v[116:119], v[112:115], v[16:31]
    s_lshl_b32 s24, s38, 7
    s_add_u32 s24, s24, 156160
    s_lshl_b32 s25, s39, 10
    s_add_u32 s25, s25, s24
    v_lshl_add_u32 v6, v1, 2, s25
    v_mfma_f32_32x32x16_bf16 v[32:47], v[120:123], v[112:115], v[32:47]
    s_mov_b64 exec, 0xffff
    ds_write2_b32 v6, v64, v65 offset0:0 offset1:16
    ds_write2_b32 v6, v68, v69 offset0:64 offset1:80
    ds_write2_b32 v6, v72, v73 offset0:128 offset1:144
    s_mov_b64 exec, -1
    v_mfma_f32_32x32x16_bf16 v[48:63], v[112:115], v[124:127], v[48:63]
    v_lshl_add_u32 v7, v4, 4, s24
    v_lshl_add_u32 v8, v3, 2, s24
    s_lshl_b32 s24, s39, 7
    s_add_u32 s24, s24, 155648
    v_lshl_add_u32 v10, v3, 2, s24
    v_lshl_add_u32 v11, v4, 4, s24
    s_waitcnt lgkmcnt(0)
    s_barrier
    ds_read_b32 v12, v10
    ds_read_b32 v14, v10 offset:256
    ds_read_b128 v[96:99], v7 offset:256
    ds_read_b128 v[200:203], v7 offset:1280
    ds_read_b128 v[100:103], v7 offset:288
    ds_read_b128 v[204:207], v7 offset:1312
    v_mfma_f32_32x32x16_bf16 v[16:31], v[132:135], v[128:131], v[16:31]
    ds_read_b128 v[104:107], v7 offset:320
    ds_read_b128 v[208:211], v7 offset:1344
    ds_read_b128 v[108:111], v7 offset:352
    ds_read_b128 v[212:215], v7 offset:1376
    ds_read_b128 v[80:83], v7 offset:0
    ds_read_b128 v[216:219], v7 offset:1024
    v_mfma_f32_32x32x16_bf16 v[32:47], v[136:139], v[128:131], v[32:47]
    ds_read_b128 v[84:87], v7 offset:32
    ds_read_b128 v[220:223], v7 offset:1056
    ds_read_b128 v[88:91], v7 offset:64
    ds_read_b128 v[224:227], v7 offset:1088
    ds_read_b128 v[92:95], v7 offset:96
    ds_read_b128 v[228:231], v7 offset:1120
    ds_read2st64_b32 v[64:65], v8 offset0:2 offset1:6
    v_mfma_f32_32x32x16_bf16 v[48:63], v[128:131], v[140:143], v[48:63]
    ds_read_b128 v[184:187], v11 offset:256
    ds_read_b128 v[168:171], v11 offset:0
    ds_read_b128 v[188:191], v11 offset:288
    ds_read_b128 v[172:175], v11 offset:32
    ds_read_b128 v[192:195], v11 offset:320
    ds_read_b128 v[176:179], v11 offset:64
    ds_read_b128 v[196:199], v11 offset:352
    ds_read_b128 v[180:183], v11 offset:96
    s_lshl_b32 s24, s37, 1
    s_add_u32 s24, s24, s38
    s_mul_i32 s32, s24, 557056
    s_lshl_b32 s25, s36, 1
    s_add_u32 s25, s25, s39
    s_lshl_b32 s25, s25, 10
    s_add_u32 s32, s32, s25
    s_add_u32 s34, s32, 0x34000
    s_add_u32 s32, s32, 0x10000
    s_add_u32 s33, s32, 278528
    s_mul_i32 s30, s36, 278528
    s_lshl_b32 s24, s24, 11
    s_add_u32 s30, s30, s24
    s_lshl_b32 s24, s39, 15
    s_add_u32 s30, s30, s24
    s_add_u32 s30, s30, 0x0
    v_and_b32 v6, 0x33f, v9
    v_and_b32 v7, 64, v9
    v_lshl_or_b32 v6, v7, 1, v6
    v_and_b32 v7, 128, v9
    v_lshrrev_b32 v7, 1, v7
    v_or_b32 v6, v6, v7
    s_waitcnt lgkmcnt(15)
    v_pk_add_f32 v[96:97], v[96:97], v[200:201]
    v_pk_add_f32 v[98:99], v[98:99], v[202:203]
    v_pk_add_f32 v[100:101], v[100:101], v[204:205]
    v_pk_add_f32 v[102:103], v[102:103], v[206:207]
    v_pk_add_f32 v[104:105], v[104:105], v[208:209]
    v_pk_add_f32 v[106:107], v[106:107], v[210:211]
    v_pk_add_f32 v[108:109], v[108:109], v[212:213]
    v_pk_add_f32 v[110:111], v[110:111], v[214:215]
    v_pk_mul_f32 v[96:97], v[96:97], v[14:15] op_sel_hi:[1,0]
    v_pk_mul_f32 v[98:99], v[98:99], v[14:15] op_sel_hi:[1,0]
    v_pk_mul_f32 v[100:101], v[100:101], v[14:15] op_sel_hi:[1,0]
    v_pk_mul_f32 v[102:103], v[102:103], v[14:15] op_sel_hi:[1,0]
    v_pk_mul_f32 v[104:105], v[104:105], v[14:15] op_sel_hi:[1,0]
    v_pk_mul_f32 v[106:107], v[106:107], v[14:15] op_sel_hi:[1,0]
    v_pk_mul_f32 v[108:109], v[108:109], v[14:15] op_sel_hi:[1,0]
    v_pk_mul_f32 v[110:111], v[110:111], v[14:15] op_sel_hi:[1,0]
    v_pk_fma_f32 v[32:33], v[32:33], v[12:13], v[96:97] op_sel_hi:[1,0,1]
    v_pk_fma_f32 v[34:35], v[34:35], v[12:13], v[98:99] op_sel_hi:[1,0,1]
    v_pk_fma_f32 v[36:37], v[36:37], v[12:13], v[100:101] op_sel_hi:[1,0,1]
    v_pk_fma_f32 v[38:39], v[38:39], v[12:13], v[102:103] op_sel_hi:[1,0,1]
    v_pk_fma_f32 v[40:41], v[40:41], v[12:13], v[104:105] op_sel_hi:[1,0,1]
    v_pk_fma_f32 v[42:43], v[42:43], v[12:13], v[106:107] op_sel_hi:[1,0,1]
    v_pk_fma_f32 v[44:45], v[44:45], v[12:13], v[108:109] op_sel_hi:[1,0,1]
    v_pk_fma_f32 v[46:47], v[46:47], v[12:13], v[110:111] op_sel_hi:[1,0,1]
    v_cvt_pk_bf16_f32 v144, v32, v33
    v_cvt_pk_bf16_f32 v148, v40, v41
    v_or_b32_sdwa v144, v32, 1 dst_sel:WORD_0 dst_unused:UNUSED_PRESERVE src0_sel:WORD_1 src1_sel:DWORD
    v_or_b32_sdwa v148, v40, 1 dst_sel:WORD_0 dst_unused:UNUSED_PRESERVE src0_sel:WORD_1 src1_sel:DWORD
    v_cvt_pk_bf16_f32 v145, v34, v35
    v_cvt_pk_bf16_f32 v146, v36, v37
    v_cvt_pk_bf16_f32 v147, v38, v39
    v_cvt_pk_bf16_f32 v149, v42, v43
    v_cvt_pk_bf16_f32 v150, v44, v45
    v_cvt_pk_bf16_f32 v151, v46, v47
    buffer_store_dwordx4 v[144:147], v6, s[8:11], s32 offen sc1
    buffer_store_dwordx4 v[148:151], v6, s[8:11], s33 offen sc1
    v_mul_f32 v12, 0x3eb8aa3b, v12
    v_mul_f32 v14, 0x3eb8aa3b, v14
    s_waitcnt lgkmcnt(9)
    v_pk_add_f32 v[80:81], v[80:81], v[216:217]
    v_pk_add_f32 v[82:83], v[82:83], v[218:219]
    v_pk_add_f32 v[84:85], v[84:85], v[220:221]
    v_pk_add_f32 v[86:87], v[86:87], v[222:223]
    v_pk_add_f32 v[88:89], v[88:89], v[224:225]
    v_pk_add_f32 v[90:91], v[90:91], v[226:227]
    v_pk_add_f32 v[92:93], v[92:93], v[228:229]
    v_pk_add_f32 v[94:95], v[94:95], v[230:231]
    v_pk_mul_f32 v[80:81], v[80:81], v[14:15] op_sel_hi:[1,0]
    v_pk_mul_f32 v[82:83], v[82:83], v[14:15] op_sel_hi:[1,0]
    v_pk_mul_f32 v[84:85], v[84:85], v[14:15] op_sel_hi:[1,0]
    v_pk_mul_f32 v[86:87], v[86:87], v[14:15] op_sel_hi:[1,0]
    v_pk_mul_f32 v[88:89], v[88:89], v[14:15] op_sel_hi:[1,0]
    v_pk_mul_f32 v[90:91], v[90:91], v[14:15] op_sel_hi:[1,0]
    v_pk_mul_f32 v[92:93], v[92:93], v[14:15] op_sel_hi:[1,0]
    v_pk_mul_f32 v[94:95], v[94:95], v[14:15] op_sel_hi:[1,0]
    v_pk_fma_f32 v[16:17], v[16:17], v[12:13], v[80:81] op_sel_hi:[1,0,1]
    v_pk_fma_f32 v[18:19], v[18:19], v[12:13], v[82:83] op_sel_hi:[1,0,1]
    v_pk_fma_f32 v[20:21], v[20:21], v[12:13], v[84:85] op_sel_hi:[1,0,1]
    v_pk_fma_f32 v[22:23], v[22:23], v[12:13], v[86:87] op_sel_hi:[1,0,1]
    v_pk_fma_f32 v[24:25], v[24:25], v[12:13], v[88:89] op_sel_hi:[1,0,1]
    v_pk_fma_f32 v[26:27], v[26:27], v[12:13], v[90:91] op_sel_hi:[1,0,1]
    v_pk_fma_f32 v[28:29], v[28:29], v[12:13], v[92:93] op_sel_hi:[1,0,1]
    v_pk_fma_f32 v[30:31], v[30:31], v[12:13], v[94:95] op_sel_hi:[1,0,1]
    v_cvt_pk_bf16_f32 v152, v16, v17
    v_cvt_pk_bf16_f32 v156, v24, v25
    v_or_b32_sdwa v152, v16, 1 dst_sel:WORD_0 dst_unused:UNUSED_PRESERVE src0_sel:WORD_1 src1_sel:DWORD
    v_or_b32_sdwa v156, v24, 1 dst_sel:WORD_0 dst_unused:UNUSED_PRESERVE src0_sel:WORD_1 src1_sel:DWORD
    v_cvt_pk_bf16_f32 v153, v18, v19
    v_cvt_pk_bf16_f32 v154, v20, v21
    v_cvt_pk_bf16_f32 v155, v22, v23
    v_cvt_pk_bf16_f32 v157, v26, v27
    v_cvt_pk_bf16_f32 v158, v28, v29
    v_cvt_pk_bf16_f32 v159, v30, v31
    buffer_store_dwordx4 v[152:155], v9, s[8:11], s30 offen sc1
    buffer_store_dwordx4 v[156:159], v9, s[8:11], s30 offen offset:1024 sc1
    v_lshrrev_b32 v6, 4, v3
    v_mul_u32_u24 v6, 278528, v6
    v_and_b32 v7, 15, v3
    v_lshl_add_u32 v6, v7, 4, v6
    v_lshl_add_u32 v6, v4, 8, v6
    s_waitcnt lgkmcnt(0)
    v_add_f32 v64, v64, v65
    v_pk_mul_f32 v[184:185], v[184:185], v[64:65] op_sel_hi:[1,0]
    v_pk_mul_f32 v[186:187], v[186:187], v[64:65] op_sel_hi:[1,0]
    v_pk_mul_f32 v[188:189], v[188:189], v[64:65] op_sel_hi:[1,0]
    v_pk_mul_f32 v[190:191], v[190:191], v[64:65] op_sel_hi:[1,0]
    v_pk_mul_f32 v[192:193], v[192:193], v[64:65] op_sel_hi:[1,0]
    v_pk_mul_f32 v[194:195], v[194:195], v[64:65] op_sel_hi:[1,0]
    v_pk_mul_f32 v[196:197], v[196:197], v[64:65] op_sel_hi:[1,0]
    v_pk_mul_f32 v[198:199], v[198:199], v[64:65] op_sel_hi:[1,0]
    v_pk_fma_f32 v[48:49], v[48:49], v[168:169], v[184:185]
    v_pk_fma_f32 v[50:51], v[50:51], v[170:171], v[186:187]
    v_pk_fma_f32 v[52:53], v[52:53], v[172:173], v[188:189]
    v_pk_fma_f32 v[54:55], v[54:55], v[174:175], v[190:191]
    v_pk_fma_f32 v[56:57], v[56:57], v[176:177], v[192:193]
    v_pk_fma_f32 v[58:59], v[58:59], v[178:179], v[194:195]
    v_pk_fma_f32 v[60:61], v[60:61], v[180:181], v[196:197]
    v_pk_fma_f32 v[62:63], v[62:63], v[182:183], v[198:199]
    v_cvt_pk_bf16_f32 v160, v48, v49
    v_cvt_pk_bf16_f32 v164, v56, v57
    v_or_b32_sdwa v160, v48, 1 dst_sel:WORD_0 dst_unused:UNUSED_PRESERVE src0_sel:WORD_1 src1_sel:DWORD
    v_or_b32_sdwa v164, v56, 1 dst_sel:WORD_0 dst_unused:UNUSED_PRESERVE src0_sel:WORD_1 src1_sel:DWORD
    v_cvt_pk_bf16_f32 v161, v50, v51
    v_cvt_pk_bf16_f32 v162, v52, v53
    v_cvt_pk_bf16_f32 v163, v54, v55
    v_cvt_pk_bf16_f32 v165, v58, v59
    v_cvt_pk_bf16_f32 v166, v60, v61
    v_cvt_pk_bf16_f32 v167, v62, v63
    buffer_store_dwordx4 v[160:163], v6, s[8:11], s34 offen sc1
    buffer_store_dwordx4 v[164:167], v6, s[8:11], s34 offen offset:512 sc1
    s_setprio 0
M_start:
    s_load_dwordx2 s[12:13], s[0:1], 16
    s_load_dwordx2 s[20:21], s[0:1], 48
    s_load_dwordx2 s[24:25], s[0:1], 56
    s_load_dwordx2 s[16:17], s[0:1], 0
    s_load_dwordx2 s[4:5], s[0:1], 64
    s_load_dwordx4 s[48:51], s[0:1], 32
    v_lshrrev_b32 v2, 6, v0
    v_and_b32 v1, 63, v0
    v_readfirstlane_b32 s3, v2
    v_and_b32 v3, 31, v0
    v_lshrrev_b32 v4, 5, v1
    v_lshlrev_b32 v1, 4, v1
    s_and_b32 s28, s2, 7
    s_lshl_b32 s28, s28, 2
    s_bfe_u32 s29, s2, 0x20003
    s_add_u32 s28, s28, s29
    s_lshr_b32 s30, s2, 5
    s_mul_i32 s36, s28, 278528
    s_lshl_b32 s41, s3, 10
    s_add_u32 s40, s36, s41
    s_add_u32 s38, s40, 0x10000
    s_add_u32 s39, s40, 0x34000
    s_lshl_b32 s42, s30, 2
    s_lshr_b32 s43, s3, 1
    s_add_u32 s42, s42, s43
    s_mul_i32 s42, s42, 278528
    s_and_b32 s43, s3, 1
    s_lshl_b32 s43, s43, 15
    s_add_u32 s42, s42, s43
    s_lshl_b32 s43, s28, 10
    s_add_u32 s53, s42, s43
    s_mov_b32 s14, 0x80000
    s_mov_b32 s15, 0x00020000
    s_mov_b32 s22, 0x158000
    s_mov_b32 s23, 0x00020000
    s_mov_b32 s26, 0x158000
    s_mov_b32 s27, 0x00020000
    s_mov_b32 s18, 0x200000
    s_mov_b32 s19, 0x00020000
    s_mov_b32 s6, 0x200000
    s_mov_b32 s7, 0x00020000
    s_and_b32 s31, s3, 1
    s_bfe_u32 s35, s3, 0x10001
    s_add_u32 s37, s30, 28
    s_min_u32 s42, s30, 3
    s_add_u32 s37, s37, s42
    s_movk_i32 s46, 2752
    v_lshrrev_b32 v2, 2, v1
    v_and_b32 v2, 64, v2
    v_and_b32 v10, 0x70, v1
    v_xor_b32 v10, v10, v2
    v_lshrrev_b32 v2, 7, v1
    v_mad_u32_u24 v11, v2, s46, v10
    v_lshl_add_u32 v10, v2, 10, v10
    s_mov_b32 s63, 0x00020000
    s_mov_b32 s32, 0x0000ffff
    s_mov_b32 s33, 0x0000ffff
    s_mov_b32 s34, 30000
    v_mov_b32 v7, 0xdddd
    v_and_b32 v2, 27, v3
    v_cmp_eq_u32 vcc, 16, v2
    v_mov_b32 v2, 0x3f803f80
    s_nop 0
    v_cndmask_b32 v72, 0, v2, vcc
    v_mov_b32 v73, v72
    v_mov_b32 v74, v72
    v_mov_b32 v75, v72
    v_mov_b32 v76, v72
    v_mov_b32 v77, v72
    v_mov_b32 v78, v72
    v_mov_b32 v79, v72
    v_mov_b32 v80, v72
    v_mov_b32 v81, v72
    v_mov_b32 v82, v72
    v_mov_b32 v83, v72
    v_mov_b32 v84, v72
    v_mov_b32 v85, v72
    v_mov_b32 v86, v72
    v_mov_b32 v87, v72
    v_mov_b32 v16, 0
    v_mov_b32 v17, 0
    v_mov_b32 v18, 0
    v_mov_b32 v19, 0
    v_mov_b32 v20, 0
    v_mov_b32 v21, 0
    v_mov_b32 v22, 0
    v_mov_b32 v23, 0
    v_mov_b32 v24, 0
    v_mov_b32 v25, 0
    v_mov_b32 v26, 0
    v_mov_b32 v27, 0
    v_mov_b32 v28, 0
    v_mov_b32 v29, 0
    v_mov_b32 v30, 0
    v_mov_b32 v31, 0
    v_mov_b32 v56, 0
    v_mov_b32 v57, 0
    v_mov_b32 v58, 0
    v_mov_b32 v59, 0
    v_mov_b32 v60, 0
    v_mov_b32 v61, 0
    v_mov_b32 v62, 0
    v_mov_b32 v63, 0
    v_add_u32 v5, 65536, v1
    v_add_u32 v8, 81920, v1
    v_and_b32 v6, 15, v3
    v_lshlrev_b32 v6, 4, v6
    v_lshl_add_u32 v6, v4, 8, v6
    v_add_u32 v9, 90112, v6
    v_add_u32 v6, 73728, v6
    v_bfe_u32 v91, v1, 6, 2
    v_lshl_add_u32 v91, v4, 2, v91
    v_lshlrev_b32 v91, 7, v91
    v_bfe_u32 v2, v1, 4, 2
    v_lshl_add_u32 v91, v2, 3, v91
    v_bfe_u32 v2, v1, 8, 1
    v_lshl_add_u32 v91, v2, 5, v91
    v_bfe_u32 v2, v1, 7, 1
    v_lshl_add_u32 v91, v2, 6, v91
    s_lshl_b32 s42, s31, 6
    v_xor_b32 v91, s42, v91
    s_lshl_b32 s42, s31, 14
    s_lshl_b32 s43, s35, 15
    s_add_u32 s43, s43, 98304
    s_cmp_lt_u32 s3, 4
    s_cselect_b32 s42, s42, s43
    s_cselect_b32 s43, 64, 0x4000
    v_add_u32 v88, s42, v91
    v_xor_b32 v89, s43, v88
    s_lshl_b32 s42, s31, 13
    s_add_u32 s42, s42, 32768
    v_add_u32 v90, s42, v91
    v_xor_b32 v91, 64, v90
    v_readlane_b32 s97, v235, 63
    s_waitcnt lgkmcnt(0)
    s_xor_b32 s42, s97, 1
    s_or_b32 s42, s42, 0x10000
    v_mov_b32 v2, s42
    s_add_u32 s59, s41, 49152
    s_lshl_b32 s43, s30, 7
    s_lshl_b32 s40, s35, 18
    s_lshl_b32 s42, s31, 16
    s_add_u32 s40, s40, s42
    s_add_u32 s40, s40, 0
    s_mul_i32 s42, s31, 163840
    s_add_u32 s42, s42, 851968
    s_cmp_lt_u32 s3, 4
    s_cselect_b32 s40, s40, s42
    s_cselect_b32 s60, s12, s24
    s_cselect_b32 s61, s13, s25
    s_cselect_b32 s62, s14, s26
    s_add_u32 s40, s40, s43
    s_lshl_b32 m0, s3, 13
    s_movk_i32 s46, 8192
    v_mov_b32 v0, v10
    s_cmp_lt_u32 s3, 6
    s_cselect_b64 vcc, -1, 0
    s_cbranch_scc1 AT_mp0
    s_cmp_eq_u32 s3, 6
    s_cselect_b32 s60, s20, s12
    s_cselect_b32 s61, s21, s13
    s_cselect_b32 s42, 43, 16
    s_lshl_b32 s62, s42, 15
    s_mul_i32 s40, s42, s2
    s_lshl_b32 s40, s40, 7
    s_sub_u32 s42, s42, 1
    v_lshrrev_b32 v0, 4, v1
    v_min_u32 v0, s42, v0
    v_lshlrev_b32 v0, 7, v0
AT_mp0:
    s_mov_b32 s58, m0
    s_mov_b64 s[56:57], vcc
    s_cmp_lt_u32 s3, 4
    s_cbranch_scc1 AP_w
    s_waitcnt vmcnt(0)
AP_w:
    s_waitcnt vmcnt(0)
    s_barrier
    s_cmp_lg_u32 s3, 0
    s_cbranch_scc1 AP_ok
    buffer_store_dword v2, off, s[8:11], s96 sc1
    s_sleep 12
AP_again:
    buffer_load_dword v240, v236, s[8:11], s99 offen sc1
    s_waitcnt vmcnt(0)
    v_cmpx_eq_u32 vcc, v235, v240
    s_cbranch_execz AP_ok
    s_cmp_eq_u32 s34, 0
    s_cbranch_scc1 AP_ok
    s_sub_u32 s34, s34, 1
    s_mov_b32 s47, 1
    s_sleep 3
    s_and_b32 s98, s34, 63
    s_cbranch_scc1 AP_again
    v_mov_b32 v2, s34
    buffer_store_dword v2, off, s[8:11], s96 sc1
    s_branch AP_again
AP_ok:
    s_mov_b64 exec, -1
    s_barrier
    buffer_load_dwordx4 v[12:15], v1, s[8:11], s53 offen
    s_add_u32 m0, s41, 65536
    s_nop 0
    buffer_load_dwordx4 v1, s[8:11], s38 offen lds
    s_add_u32 m0, s41, 73728
    s_nop 0
    buffer_load_dwordx4 v1, s[8:11], s39 offen lds
    s_add_u32 m0, s41, 81920
    s_add_u32 s38, s38, 8192
    buffer_load_dwordx4 v1, s[8:11], s38 offen lds
    s_add_u32 m0, s41, 90112
    s_add_u32 s39, s39, 8192
    buffer_load_dwordx4 v1, s[8:11], s39 offen lds
    s_mov_b32 m0, s58
    s_mov_b64 vcc, s[56:57]
    s_waitcnt vmcnt(0)
    s_barrier
    ds_read_b128 v[64:67], v5
    ds_read_b128 v[68:71], v5 offset:1024
    s_mov_b64 exec, s[32:33]
    ds_read_b128 v[72:75], v6
    ds_read_b128 v[76:79], v6 offset:512
    s_mov_b64 exec, -1
    s_waitcnt lgkmcnt(0)
    v_mfma_f32_32x32x16_bf16 v[32:47], v[64:67], v[12:15], 0
    s_mov_b32 s29, 0
    s_nop 7
    s_nop 3
.p2align 6
AT_loop:
    s_setprio 3
    v_exp_f32 v32, v32
    v_exp_f32 v33, v33
    v_smfmac_f32_32x32x32_bf16 v[16:31], v[84:87], v[56:63], v7
    s_cmp_eq_u32 s59, 0
    s_cbranch_scc1 AT_k1
    s_mov_b32 s58, m0
    s_add_u32 m0, s59, 0
    s_add_u32 s38, s38, 8192
    buffer_load_dwordx4 v1, s[8:11], s38 offen lds
    s_mov_b32 m0, s58
AT_k1:
    s_mov_b64 exec, s[32:33]
    ds_read_b128 v[80:83], v6 offset:1024
    ds_read_b128 v[84:87], v6 offset:1536
    s_mov_b64 exec, -1
    v_exp_f32 v34, v34
    v_exp_f32 v35, v35
    v_exp_f32 v36, v36
    v_exp_f32 v37, v37
    s_waitcnt lgkmcnt(2)
    v_mfma_f32_32x32x16_bf16 v[48:63], v[68:71], v[12:15], 0
    ds_read_b128 v[64:67], v5 offset:2048
    v_exp_f32 v38, v38
    v_exp_f32 v39, v39
    v_exp_f32 v40, v40
    v_exp_f32 v41, v41
    v_exp_f32 v42, v42
    v_smfmac_f32_32x32x32_bf16 v[16:31], v[72:75], v[32:39], v7
    s_cbranch_vccz AT_n0
    buffer_load_dwordx4 v0, s[60:63], s40 offen lds
    s_addk_i32 m0, 1024
    s_add_u32 s40, s40, s46
AT_n0:
    v_exp_f32 v43, v43
    v_exp_f32 v44, v44
    v_exp_f32 v45, v45
    v_exp_f32 v46, v46
    v_exp_f32 v47, v47
    v_exp_f32 v48, v48
    v_exp_f32 v49, v49
    v_smfmac_f32_32x32x32_bf16 v[16:31], v[76:79], v[40:47], v7
    s_cmp_eq_u32 s59, 0
    s_cbranch_scc1 AT_k2
    s_mov_b32 s58, m0
    s_add_u32 m0, s59, 8192
    s_add_u32 s39, s39, 8192
    buffer_load_dwordx4 v1, s[8:11], s39 offen lds
    s_mov_b32 m0, s58
AT_k2:
    s_mov_b64 exec, s[32:33]
    ds_read_b128 v[72:75], v6 offset:2048
    ds_read_b128 v[76:79], v6 offset:2560
    s_mov_b64 exec, -1
    v_exp_f32 v50, v50
    v_exp_f32 v51, v51
    v_exp_f32 v52, v52
    v_exp_f32 v53, v53
    s_waitcnt lgkmcnt(2)
    v_mfma_f32_32x32x16_bf16 v[32:47], v[64:67], v[12:15], 0
    ds_read_b128 v[68:71], v5 offset:3072
    v_exp_f32 v54, v54
    v_exp_f32 v55, v55
    v_exp_f32 v56, v56
    v_exp_f32 v57, v57
    v_exp_f32 v58, v58
    v_smfmac_f32_32x32x32_bf16 v[16:31], v[80:83], v[48:55], v7
    s_cbranch_vccz AT_n1
    buffer_load_dwordx4 v0, s[60:63], s40 offen lds
    s_addk_i32 m0, 1024
    s_add_u32 s40, s40, s46
AT_n1:
    v_exp_f32 v59, v59
    v_exp_f32 v60, v60
    v_exp_f32 v61, v61
    v_exp_f32 v62, v62
    v_exp_f32 v63, v63
    v_exp_f32 v32, v32
    v_exp_f32 v33, v33
    v_smfmac_f32_32x32x32_bf16 v[16:31], v[84:87], v[56:63], v7
    s_mov_b64 exec, s[32:33]
    ds_read_b128 v[80:83], v6 offset:3072
    ds_read_b128 v[84:87], v6 offset:3584
    s_mov_b64 exec, -1
    v_exp_f32 v34, v34
    v_exp_f32 v35, v35
    v_exp_f32 v36, v36
    v_exp_f32 v37, v37
    s_waitcnt lgkmcnt(2)
    v_mfma_f32_32x32x16_bf16 v[48:63], v[68:71], v[12:15], 0
    ds_read_b128 v[64:67], v5 offset:4096
    v_exp_f32 v38, v38
    v_exp_f32 v39, v39
    v_exp_f32 v40, v40
    v_exp_f32 v41, v41
    v_exp_f32 v42, v42
    v_smfmac_f32_32x32x32_bf16 v[16:31], v[72:75], v[32:39], v7
    s_cbranch_vccz AT_n2
    buffer_load_dwordx4 v0, s[60:63], s40 offen lds
    s_addk_i32 m0, 1024
    s_add_u32 s40, s40, s46
AT_n2:
    v_exp_f32 v43, v43
    v_exp_f32 v44, v44
    v_exp_f32 v45, v45
    v_exp_f32 v46, v46
    v_exp_f32 v47, v47
    v_exp_f32 v48, v48
    v_exp_f32 v49, v49
    v_smfmac_f32_32x32x32_bf16 v[16:31], v[76:79], v[40:47], v7
    s_mov_b64 exec, s[32:33]
    ds_read_b128 v[72:75], v6 offset:4096
    ds_read_b128 v[76:79], v6 offset:4608
    s_mov_b64 exec, -1
    v_exp_f32 v50, v50
    v_exp_f32 v51, v51
    v_exp_f32 v52, v52
    v_exp_f32 v53, v53
    s_waitcnt lgkmcnt(2)
    v_mfma_f32_32x32x16_bf16 v[32:47], v[64:67], v[12:15], 0
    ds_read_b128 v[68:71], v5 offset:5120
    v_exp_f32 v54, v54
    v_exp_f32 v55, v55
    v_exp_f32 v56, v56
    v_exp_f32 v57, v57
    v_exp_f32 v58, v58
    v_smfmac_f32_32x32x32_bf16 v[16:31], v[80:83], v[48:55], v7
    s_cbranch_vccz AT_e3
    buffer_load_dwordx4 v0, s[60:63], s40 offen lds
    s_addk_i32 m0, 1024
    s_add_u32 s40, s40, s46
AT_n3:
    v_exp_f32 v59, v59
    v_exp_f32 v60, v60
    v_exp_f32 v61, v61
    v_exp_f32 v62, v62
    v_exp_f32 v63, v63
    v_exp_f32 v32, v32
    v_exp_f32 v33, v33
    v_smfmac_f32_32x32x32_bf16 v[16:31], v[84:87], v[56:63], v7
    s_mov_b64 exec, s[32:33]
    ds_read_b128 v[80:83], v6 offset:5120
    ds_read_b128 v[84:87], v6 offset:5632
    s_mov_b64 exec, -1
    v_exp_f32 v34, v34
    v_exp_f32 v35, v35
    v_exp_f32 v36, v36
    v_exp_f32 v37, v37
    s_waitcnt lgkmcnt(2)
    v_mfma_f32_32x32x16_bf16 v[48:63], v[68:71], v[12:15], 0
    ds_read_b128 v[64:67], v5 offset:6144
    v_exp_f32 v38, v38
    v_exp_f32 v39, v39
    v_exp_f32 v40, v40
    v_exp_f32 v41, v41
    v_exp_f32 v42, v42
    v_smfmac_f32_32x32x32_bf16 v[16:31], v[72:75], v[32:39], v7
    s_cbranch_vccz AT_n4
    buffer_load_dwordx4 v0, s[60:63], s40 offen lds
    s_addk_i32 m0, 1024
    s_add_u32 s40, s40, s46
AT_n4:
    v_exp_f32 v43, v43
    v_exp_f32 v44, v44
    v_exp_f32 v45, v45
    v_exp_f32 v46, v46
    v_exp_f32 v47, v47
    v_exp_f32 v48, v48
    v_exp_f32 v49, v49
    v_smfmac_f32_32x32x32_bf16 v[16:31], v[76:79], v[40:47], v7
    s_mov_b64 exec, s[32:33]
    ds_read_b128 v[72:75], v6 offset:6144
    ds_read_b128 v[76:79], v6 offset:6656
    s_mov_b64 exec, -1
    v_exp_f32 v50, v50
    v_exp_f32 v51, v51
    v_exp_f32 v52, v52
    v_exp_f32 v53, v53
    s_waitcnt lgkmcnt(2)
    v_mfma_f32_32x32x16_bf16 v[32:47], v[64:67], v[12:15], 0
    ds_read_b128 v[68:71], v5 offset:7168
    v_exp_f32 v54, v54
    v_exp_f32 v55, v55
    v_exp_f32 v56, v56
    v_exp_f32 v57, v57
    v_exp_f32 v58, v58
    v_smfmac_f32_32x32x32_bf16 v[16:31], v[80:83], v[48:55], v7
    s_cbranch_vccz AT_n5
    buffer_load_dwordx4 v0, s[60:63], s40 offen lds
    s_addk_i32 m0, 1024
    s_add_u32 s40, s40, s46
AT_n5:
    v_exp_f32 v59, v59
    v_exp_f32 v60, v60
    v_exp_f32 v61, v61
    v_exp_f32 v62, v62
    v_exp_f32 v63, v63
    s_setprio 2
    v_exp_f32 v32, v32
    v_exp_f32 v33, v33
    v_smfmac_f32_32x32x32_bf16 v[16:31], v[84:87], v[56:63], v7
    s_mov_b64 exec, s[32:33]
    ds_read_b128 v[80:83], v6 offset:7168
    ds_read_b128 v[84:87], v6 offset:7680
    s_mov_b64 exec, -1
    v_exp_f32 v34, v34
    v_exp_f32 v35, v35
    v_exp_f32 v36, v36
    v_exp_f32 v37, v37
    s_waitcnt lgkmcnt(2)
    v_mfma_f32_32x32x16_bf16 v[48:63], v[68:71], v[12:15], 0
    ds_read_b128 v[64:67], v8 offset:0
    v_exp_f32 v38, v38
    v_exp_f32 v39, v39
    v_exp_f32 v40, v40
    v_exp_f32 v41, v41
    v_exp_f32 v42, v42
    v_smfmac_f32_32x32x32_bf16 v[16:31], v[72:75], v[32:39], v7
    s_cbranch_vccz AT_n6
    buffer_load_dwordx4 v0, s[60:63], s40 offen lds
    s_addk_i32 m0, 1024
    s_add_u32 s40, s40, s46
AT_n6:
    v_exp_f32 v43, v43
    v_exp_f32 v44, v44
    v_exp_f32 v45, v45
    v_exp_f32 v46, v46
    v_exp_f32 v47, v47
    s_setprio 1
    v_exp_f32 v48, v48
    v_exp_f32 v49, v49
    v_smfmac_f32_32x32x32_bf16 v[16:31], v[76:79], v[40:47], v7
    s_mov_b64 exec, s[32:33]
    ds_read_b128 v[72:75], v9 offset:0
    ds_read_b128 v[76:79], v9 offset:512
    s_mov_b64 exec, -1
    v_exp_f32 v50, v50
    v_exp_f32 v51, v51
    v_exp_f32 v52, v52
    v_exp_f32 v53, v53
    s_waitcnt lgkmcnt(2)
    v_mfma_f32_32x32x16_bf16 v[32:47], v[64:67], v[12:15], 0
    ds_read_b128 v[68:71], v8 offset:1024
    s_setprio 0
    v_exp_f32 v54, v54
    v_exp_f32 v55, v55
    v_exp_f32 v56, v56
    v_exp_f32 v57, v57
    v_exp_f32 v58, v58
    v_smfmac_f32_32x32x32_bf16 v[16:31], v[80:83], v[48:55], v7
    s_cbranch_vccz AT_n7
    buffer_load_dwordx4 v0, s[60:63], s40 offen lds
    s_addk_i32 m0, 1024
    s_add_u32 s40, s40, s46
AT_n7:
    v_exp_f32 v59, v59
    v_exp_f32 v60, v60
    v_exp_f32 v61, v61
    v_exp_f32 v62, v62
    v_exp_f32 v63, v63
    v_mov_b32 v5, v8
    v_mov_b32 v6, v9
    s_add_u32 s29, s29, 1
    s_cmp_gt_u32 s29, 4
    s_cbranch_scc1 AT_hi
    s_cmp_gt_u32 s29, 2
    s_cbranch_scc1 AT_s23
    s_cmp_eq_u32 s29, 2
    s_cbranch_scc1 AT_s1
    s_cbranch_vccz AT_w1131
    s_waitcnt vmcnt(7)
    s_branch AT_x1131
AT_w1131:
    s_waitcnt vmcnt(1)
AT_x1131:
    s_barrier
    s_add_u32 s59, s41, 65536
    s_lshl_b32 s43, s30, 7
    s_and_b32 s40, s3, 3
    s_mul_i32 s40, s40, 176128
    s_lshl_b32 s42, s30, 8
    s_add_u32 s40, s40, s42
    s_lshr_b32 s42, s3, 2
    s_lshl_b32 s42, s42, 7
    s_add_u32 s40, s40, s42
    s_add_u32 s40, s40, 0
    s_mov_b32 s60, s20
    s_mov_b32 s61, s21
    s_mov_b32 s62, s22
    s_lshl_b32 m0, s3, 13
    s_add_u32 m0, m0, 98304
    s_movk_i32 s46, 22016
    v_mov_b32 v0, v11
    s_mov_b64 vcc, -1
    v_add_u32 v8, 0xffff8000, v8
    v_add_u32 v9, 0xffff8000, v9
    s_branch AT_loop
AT_e3:
    buffer_load_dword v2, v0, s[60:63], s40 offen
    s_branch AT_n3
AT_s1:
    s_waitcnt vmcnt(7)
    s_barrier
    s_add_u32 s59, s41, 81920
    s_cmp_lt_u32 s3, 4
    s_cbranch_scc1 AT_r0_m
    s_cmp_eq_u32 s35, 0
    s_cbranch_scc0 AT_r0
    ds_read_b64_tr_b16 v[96:97], v90 offset:0
    ds_read_b64_tr_b16 v[98:99], v90 offset:1024
    ds_read_b64_tr_b16 v[100:101], v91 offset:0
    ds_read_b64_tr_b16 v[102:103], v91 offset:1024
    ds_read_b64_tr_b16 v[104:105], v90 offset:2048
    ds_read_b64_tr_b16 v[106:107], v90 offset:3072
    ds_read_b64_tr_b16 v[108:109], v91 offset:2048
    ds_read_b64_tr_b16 v[110:111], v91 offset:3072
    ds_read_b64_tr_b16 v[112:113], v90 offset:4096
    ds_read_b64_tr_b16 v[114:115], v90 offset:5120
    ds_read_b64_tr_b16 v[116:117], v91 offset:4096
    ds_read_b64_tr_b16 v[118:119], v91 offset:5120
    ds_read_b64_tr_b16 v[120:121], v90 offset:6144
    ds_read_b64_tr_b16 v[122:123], v90 offset:7168
    ds_read_b64_tr_b16 v[124:125], v91 offset:6144
    ds_read_b64_tr_b16 v[126:127], v91 offset:7168
    s_branch AT_r0
AT_r0_m:
    ds_read_b64_tr_b16 v[128:129], v88 offset:0
    ds_read_b64_tr_b16 v[130:131], v88 offset:1024
    ds_read_b64_tr_b16 v[192:193], v89 offset:0
    ds_read_b64_tr_b16 v[194:195], v89 offset:1024
    ds_read_b64_tr_b16 v[132:133], v88 offset:2048
    ds_read_b64_tr_b16 v[134:135], v88 offset:3072
    ds_read_b64_tr_b16 v[196:197], v89 offset:2048
    ds_read_b64_tr_b16 v[198:199], v89 offset:3072
    ds_read_b64_tr_b16 v[136:137], v88 offset:4096
    ds_read_b64_tr_b16 v[138:139], v88 offset:5120
    ds_read_b64_tr_b16 v[200:201], v89 offset:4096
    ds_read_b64_tr_b16 v[202:203], v89 offset:5120
    ds_read_b64_tr_b16 v[140:141], v88 offset:6144
    ds_read_b64_tr_b16 v[142:143], v88 offset:7168
    ds_read_b64_tr_b16 v[204:205], v89 offset:6144
    ds_read_b64_tr_b16 v[206:207], v89 offset:7168
    ds_read_b64_tr_b16 v[144:145], v88 offset:8192
    ds_read_b64_tr_b16 v[146:147], v88 offset:9216
    ds_read_b64_tr_b16 v[208:209], v89 offset:8192
    ds_read_b64_tr_b16 v[210:211], v89 offset:9216
    ds_read_b64_tr_b16 v[148:149], v88 offset:10240
    ds_read_b64_tr_b16 v[150:151], v88 offset:11264
    ds_read_b64_tr_b16 v[212:213], v89 offset:10240
    ds_read_b64_tr_b16 v[214:215], v89 offset:11264
    ds_read_b64_tr_b16 v[152:153], v88 offset:12288
    ds_read_b64_tr_b16 v[154:155], v88 offset:13312
    ds_read_b64_tr_b16 v[216:217], v89 offset:12288
    ds_read_b64_tr_b16 v[218:219], v89 offset:13312
    ds_read_b64_tr_b16 v[156:157], v88 offset:14336
    ds_read_b64_tr_b16 v[158:159], v88 offset:15360
    ds_read_b64_tr_b16 v[220:221], v89 offset:14336
    ds_read_b64_tr_b16 v[222:223], v89 offset:15360
AT_r0:
    s_and_b32 s42, s28, 3
    s_lshl_b32 s42, s42, 3
    s_add_u32 s42, s42, s3
    s_mul_i32 s43, s42, 44032
    s_and_b32 s40, s2, 0xf8
    s_add_u32 s40, s40, s3
    s_mul_i32 s40, s40, 5504
    v_lshrrev_b32 v0, 4, v1
    v_min_u32 v0, 42, v0
    v_lshlrev_b32 v0, 7, v0
    s_mov_b32 s60, s24
    s_mov_b32 s61, s25
    s_mov_b32 s62, s26
    s_lshl_b32 s43, s30, 7
    s_mov_b64 vcc, 0
    v_add_u32 v8, 0x4000, v8
    v_add_u32 v9, 0x4000, v9
    s_branch AT_loop
AT_s23:
    s_cmp_eq_u32 s29, 4
    s_cbranch_scc1 AT_s3
    s_waitcnt vmcnt(1)
    s_barrier
    s_add_u32 s59, s41, 49152
    s_cmp_lt_u32 s3, 4
    s_cbranch_scc1 AT_r1
    ds_read_b64_tr_b16 v[128:129], v88 offset:0
    ds_read_b64_tr_b16 v[130:131], v88 offset:1024
    ds_read_b64_tr_b16 v[192:193], v89 offset:0
    ds_read_b64_tr_b16 v[194:195], v89 offset:1024
    ds_read_b64_tr_b16 v[132:133], v88 offset:2048
    ds_read_b64_tr_b16 v[134:135], v88 offset:3072
    ds_read_b64_tr_b16 v[196:197], v89 offset:2048
    ds_read_b64_tr_b16 v[198:199], v89 offset:3072
    ds_read_b64_tr_b16 v[136:137], v88 offset:4096
    ds_read_b64_tr_b16 v[138:139], v88 offset:5120
    ds_read_b64_tr_b16 v[200:201], v89 offset:4096
    ds_read_b64_tr_b16 v[202:203], v89 offset:5120
    ds_read_b64_tr_b16 v[140:141], v88 offset:6144
    ds_read_b64_tr_b16 v[142:143], v88 offset:7168
    ds_read_b64_tr_b16 v[204:205], v89 offset:6144
    ds_read_b64_tr_b16 v[206:207], v89 offset:7168
    ds_read_b64_tr_b16 v[144:145], v88 offset:8192
    ds_read_b64_tr_b16 v[146:147], v88 offset:9216
    ds_read_b64_tr_b16 v[208:209], v89 offset:8192
    ds_read_b64_tr_b16 v[210:211], v89 offset:9216
    ds_read_b64_tr_b16 v[148:149], v88 offset:10240
    ds_read_b64_tr_b16 v[150:151], v88 offset:11264
    ds_read_b64_tr_b16 v[212:213], v89 offset:10240
    ds_read_b64_tr_b16 v[214:215], v89 offset:11264
    ds_read_b64_tr_b16 v[152:153], v88 offset:12288
    ds_read_b64_tr_b16 v[154:155], v88 offset:13312
    ds_read_b64_tr_b16 v[216:217], v89 offset:12288
    ds_read_b64_tr_b16 v[218:219], v89 offset:13312
    ds_read_b64_tr_b16 v[156:157], v88 offset:14336
    ds_read_b64_tr_b16 v[158:159], v88 offset:15360
    ds_read_b64_tr_b16 v[220:221], v89 offset:14336
    ds_read_b64_tr_b16 v[222:223], v89 offset:15360
AT_r1:
    s_lshl_b32 s43, s30, 7
    s_lshl_b32 s40, s35, 18
    s_lshl_b32 s42, s31, 16
    s_add_u32 s40, s40, s42
    s_add_u32 s40, s40, 131072
    s_mul_i32 s42, s31, 163840
    s_add_u32 s42, s42, 1179648
    s_cmp_lt_u32 s3, 4
    s_cselect_b32 s40, s40, s42
    s_cselect_b32 s60, s12, s24
    s_cselect_b32 s61, s13, s25
    s_cselect_b32 s62, s14, s26
    s_add_u32 s40, s40, s43
    s_lshl_b32 m0, s3, 13
    s_movk_i32 s46, 8192
    v_mov_b32 v0, v10
    s_cmp_lt_u32 s3, 6
    s_cselect_b64 vcc, -1, 0
    s_cbranch_scc1 AT_mp1
    s_cmp_eq_u32 s3, 6
    s_cselect_b32 s60, s48, s50
    s_cselect_b32 s61, s49, s51
    s_cselect_b32 s42, 16, 16
    s_lshl_b32 s62, s42, 15
    s_mul_i32 s40, s42, s2
    s_lshl_b32 s40, s40, 7
    s_sub_u32 s42, s42, 1
    v_lshrrev_b32 v0, 4, v1
    v_min_u32 v0, s42, v0
    v_lshlrev_b32 v0, 7, v0
AT_mp1:
    v_add_u32 v8, 0x4000, v8
    v_add_u32 v9, 0x4000, v9
    s_branch AT_loop
AT_s3:
    s_mov_b64 s[12:13], s[48:49]
    s_cbranch_vccz AT_w1316
    s_waitcnt vmcnt(7)
    s_branch AT_x1316
AT_w1316:
    s_waitcnt vmcnt(1)
AT_x1316:
    s_barrier
    s_add_u32 s59, s41, 65536
    s_cmp_lt_u32 s3, 4
    s_cbranch_scc0 AT_s3b
    v_lshlrev_b32 v2, 10, v3
    v_lshl_add_u32 v2, v4, 3, v2
    s_lshl_b32 s42, s28, 16
    s_lshl_b32 s43, s35, 15
    s_add_u32 s42, s42, s43
    s_lshl_b32 s43, s30, 7
    s_add_u32 s42, s42, s43
    s_lshl_b32 s43, s31, 6
    s_add_u32 s42, s42, s43
    buffer_load_dwordx2 v[120:121], v2, s[16:19], s42 offen offset:0
    buffer_load_dwordx2 v[122:123], v2, s[16:19], s42 offen offset:16
    buffer_load_dwordx2 v[124:125], v2, s[16:19], s42 offen offset:32
    buffer_load_dwordx2 v[126:127], v2, s[16:19], s42 offen offset:48
AT_s3b:
    s_lshl_b32 s43, s30, 7
    s_and_b32 s40, s3, 3
    s_mul_i32 s40, s40, 176128
    s_lshl_b32 s42, s30, 8
    s_add_u32 s40, s40, s42
    s_lshr_b32 s42, s3, 2
    s_lshl_b32 s42, s42, 7
    s_add_u32 s40, s40, s42
    s_add_u32 s40, s40, 704512
    s_mov_b32 s60, s20
    s_mov_b32 s61, s21
    s_mov_b32 s62, s22
    s_lshl_b32 m0, s3, 13
    s_add_u32 m0, m0, 98304
    s_movk_i32 s46, 22016
    v_mov_b32 v0, v11
    s_mov_b64 vcc, -1
    v_add_u32 v8, 0xffff8000, v8
    v_add_u32 v9, 0xffff8000, v9
    s_branch AT_loop
AT_hi:
    s_cmp_eq_u32 s29, 8
    s_cbranch_scc1 AT_end
    s_cmp_eq_u32 s29, 7
    s_cbranch_scc1 AT_s6
    s_cmp_eq_u32 s29, 6
    s_cbranch_scc1 AT_s5
    s_mov_b64 s[16:17], s[50:51]
    s_mov_b32 s18, 0x80000
    s_waitcnt vmcnt(7) lgkmcnt(0)
    s_barrier
    s_add_u32 s59, s41, 81920
    s_cmp_lt_u32 s3, 4
    s_cbranch_scc1 AT_r2_m
    s_cmp_eq_u32 s35, 1
    s_cbranch_scc0 AT_r2
    ds_read_b64_tr_b16 v[96:97], v90 offset:0
    ds_read_b64_tr_b16 v[98:99], v90 offset:1024
    ds_read_b64_tr_b16 v[100:101], v91 offset:0
    ds_read_b64_tr_b16 v[102:103], v91 offset:1024
    ds_read_b64_tr_b16 v[104:105], v90 offset:2048
    ds_read_b64_tr_b16 v[106:107], v90 offset:3072
    ds_read_b64_tr_b16 v[108:109], v91 offset:2048
    ds_read_b64_tr_b16 v[110:111], v91 offset:3072
    ds_read_b64_tr_b16 v[112:113], v90 offset:4096
    ds_read_b64_tr_b16 v[114:115], v90 offset:5120
    ds_read_b64_tr_b16 v[116:117], v91 offset:4096
    ds_read_b64_tr_b16 v[118:119], v91 offset:5120
    ds_read_b64_tr_b16 v[120:121], v90 offset:6144
    ds_read_b64_tr_b16 v[122:123], v90 offset:7168
    ds_read_b64_tr_b16 v[124:125], v91 offset:6144
    ds_read_b64_tr_b16 v[126:127], v91 offset:7168
    s_branch AT_r2
AT_r2_m:
    ds_read_b64_tr_b16 v[160:161], v88 offset:0
    ds_read_b64_tr_b16 v[162:163], v88 offset:1024
    ds_read_b64_tr_b16 v[224:225], v89 offset:0
    ds_read_b64_tr_b16 v[226:227], v89 offset:1024
    ds_read_b64_tr_b16 v[164:165], v88 offset:2048
    ds_read_b64_tr_b16 v[166:167], v88 offset:3072
    ds_read_b64_tr_b16 v[228:229], v89 offset:2048
    ds_read_b64_tr_b16 v[230:231], v89 offset:3072
    ds_read_b64_tr_b16 v[168:169], v88 offset:4096
    ds_read_b64_tr_b16 v[170:171], v88 offset:5120
    ds_read_b64_tr_b16 v[232:233], v89 offset:4096
    ds_read_b64_tr_b16 v[234:235], v89 offset:5120
    ds_read_b64_tr_b16 v[172:173], v88 offset:6144
    ds_read_b64_tr_b16 v[174:175], v88 offset:7168
    ds_read_b64_tr_b16 v[236:237], v89 offset:6144
    ds_read_b64_tr_b16 v[238:239], v89 offset:7168
    ds_read_b64_tr_b16 v[176:177], v88 offset:8192
    ds_read_b64_tr_b16 v[178:179], v88 offset:9216
    ds_read_b64_tr_b16 v[240:241], v89 offset:8192
    ds_read_b64_tr_b16 v[242:243], v89 offset:9216
    ds_read_b64_tr_b16 v[180:181], v88 offset:10240
    ds_read_b64_tr_b16 v[182:183], v88 offset:11264
    ds_read_b64_tr_b16 v[244:245], v89 offset:10240
    ds_read_b64_tr_b16 v[246:247], v89 offset:11264
    ds_read_b64_tr_b16 v[184:185], v88 offset:12288
    ds_read_b64_tr_b16 v[186:187], v88 offset:13312
    ds_read_b64_tr_b16 v[248:249], v89 offset:12288
    ds_read_b64_tr_b16 v[250:251], v89 offset:13312
    ds_read_b64_tr_b16 v[188:189], v88 offset:14336
    ds_read_b64_tr_b16 v[190:191], v88 offset:15360
    ds_read_b64_tr_b16 v[252:253], v89 offset:14336
    ds_read_b64_tr_b16 v[254:255], v89 offset:15360
AT_r2:
    s_and_b32 s42, s28, 3
    s_lshl_b32 s42, s42, 3
    s_add_u32 s42, s42, s3
    s_mul_i32 s43, s42, 44032
    s_lshl_b32 s40, s37, 6
    s_add_u32 s43, s43, s40
    s_add_u32 s40, s43, 256
    v_lshrrev_b32 v2, 6, v1
    v_mul_u32_u24 v2, 2752, v2
    v_bfe_u32 v0, v1, 4, 1
    v_mul_u32_u24 v0, 124, v0
    v_add_u32 v0, v2, v0
    s_mov_b32 s60, s20
    s_mov_b32 s61, s21
    s_mov_b32 s62, s22
    s_lshl_b32 s43, s30, 7
    s_mov_b64 vcc, 0
    v_add_u32 v8, 0x4000, v8
    v_add_u32 v9, 0x4000, v9
    s_branch AT_loop
AT_s5:
    s_waitcnt vmcnt(1)
    s_barrier
    s_mov_b32 s59, 0
    s_cmp_lt_u32 s3, 4
    s_cbranch_scc1 AT_r3
    ds_read_b64_tr_b16 v[160:161], v88 offset:0
    ds_read_b64_tr_b16 v[162:163], v88 offset:1024
    ds_read_b64_tr_b16 v[224:225], v89 offset:0
    ds_read_b64_tr_b16 v[226:227], v89 offset:1024
    ds_read_b64_tr_b16 v[164:165], v88 offset:2048
    ds_read_b64_tr_b16 v[166:167], v88 offset:3072
    ds_read_b64_tr_b16 v[228:229], v89 offset:2048
    ds_read_b64_tr_b16 v[230:231], v89 offset:3072
    ds_read_b64_tr_b16 v[168:169], v88 offset:4096
    ds_read_b64_tr_b16 v[170:171], v88 offset:5120
    ds_read_b64_tr_b16 v[232:233], v89 offset:4096
    ds_read_b64_tr_b16 v[234:235], v89 offset:5120
    ds_read_b64_tr_b16 v[172:173], v88 offset:6144
    ds_read_b64_tr_b16 v[174:175], v88 offset:7168
    ds_read_b64_tr_b16 v[236:237], v89 offset:6144
    ds_read_b64_tr_b16 v[238:239], v89 offset:7168
    ds_read_b64_tr_b16 v[176:177], v88 offset:8192
    ds_read_b64_tr_b16 v[178:179], v88 offset:9216
    ds_read_b64_tr_b16 v[240:241], v89 offset:8192
    ds_read_b64_tr_b16 v[242:243], v89 offset:9216
    ds_read_b64_tr_b16 v[180:181], v88 offset:10240
    ds_read_b64_tr_b16 v[182:183], v88 offset:11264
    ds_read_b64_tr_b16 v[244:245], v89 offset:10240
    ds_read_b64_tr_b16 v[246:247], v89 offset:11264
    ds_read_b64_tr_b16 v[184:185], v88 offset:12288
    ds_read_b64_tr_b16 v[186:187], v88 offset:13312
    ds_read_b64_tr_b16 v[248:249], v89 offset:12288
    ds_read_b64_tr_b16 v[250:251], v89 offset:13312
    ds_read_b64_tr_b16 v[188:189], v88 offset:14336
    ds_read_b64_tr_b16 v[190:191], v88 offset:15360
    ds_read_b64_tr_b16 v[252:253], v89 offset:14336
    ds_read_b64_tr_b16 v[254:255], v89 offset:15360
AT_r3:
    s_lshl_b32 s43, s30, 7
    s_lshl_b32 s40, s3, 16
    s_add_u32 s40, s40, s43
    s_mov_b32 s60, s16
    s_mov_b32 s61, s17
    s_mov_b32 s62, s18
    s_lshl_b32 m0, s3, 13
    s_movk_i32 s46, 8192
    v_mov_b32 v0, v10
    s_mov_b64 vcc, -1
    v_add_u32 v8, 0x4000, v8
    v_add_u32 v9, 0x4000, v9
    s_branch AT_loop
AT_s6:
    s_waitcnt vmcnt(8)
    s_barrier
    s_lshl_b32 s43, s30, 7
    s_lshl_b32 s40, s3, 16
    s_add_u32 s40, s40, s43
    s_mov_b32 s60, s12
    s_mov_b32 s61, s13
    s_mov_b32 s62, s14
    s_lshl_b32 m0, s3, 13
    s_add_u32 m0, m0, 98304
    s_movk_i32 s46, 8192
    v_mov_b32 v0, v10
    s_mov_b64 vcc, -1
    v_add_u32 v8, 0xffff8000, v8
    v_add_u32 v9, 0xffff8000, v9
    s_branch AT_loop
AT_end:
    v_smfmac_f32_32x32x32_bf16 v[16:31], v[84:87], v[56:63], v7
    s_and_b32 s42, s3, 3
    s_xor_b32 s42, s42, 1
    s_lshl_b32 s42, s42, 12
    v_add_u32 v89, s42, v1
    s_mov_b32 s48, 77824
    s_mov_b32 s44, 0xbdd2d3e8
    s_mov_b32 s45, 0xbdd2d3e8
    s_lshl_b32 s57, s35, 15
    s_lshl_b32 s42, s31, 14
    s_add_u32 s57, s57, s42
    s_lshl_b32 s54, s30, 1
    s_add_u32 s54, s54, s31
    s_lshl_b32 s54, s54, 11
    s_lshl_b32 s42, s35, 15
    s_add_u32 s54, s54, s42
    s_lshr_b32 s55, s54, 3
    s_add_u32 s54, s54, s36
    s_add_u32 s55, s55, s36
    v_mul_f32 v92, 0, v16
    v_fma_f32 v92, v17, 0, v92
    v_fma_f32 v92, v18, 0, v92
    v_fma_f32 v92, v19, 0, v92
    v_fma_f32 v92, v20, 0, v92
    v_fma_f32 v92, v21, 0, v92
    v_fma_f32 v92, v22, 0, v92
    v_fma_f32 v92, v23, 0, v92
    v_add_f32 v92, v92, v24
    v_cmp_ngt_f32 vcc, 0x71800000, v92
    s_nop 0
    s_mov_b64 s[42:43], vcc
    v_cmp_nlt_f32 vcc, 0x21800000, v92
    s_nop 0
    s_or_b64 vcc, vcc, s[42:43]
    s_cbranch_vccnz AT_slow
AT_fin:
    s_nop 7
    v_rcp_f32 v92, v24
    s_nop 0
    v_pk_mul_f32 v[16:17], v[16:17], v[92:93] op_sel_hi:[1,0]
    v_pk_mul_f32 v[18:19], v[18:19], v[92:93] op_sel_hi:[1,0]
    v_pk_mul_f32 v[20:21], v[20:21], v[92:93] op_sel_hi:[1,0]
    v_pk_mul_f32 v[22:23], v[22:23], v[92:93] op_sel_hi:[1,0]
    v_cvt_pk_bf16_f32 v32, v16, v17
    v_add_u32_sdwa v32, v16, 1 dst_sel:WORD_0 dst_unused:UNUSED_PRESERVE src0_sel:WORD_1 src1_sel:DWORD
    v_cvt_pk_bf16_f32 v33, v18, v19
    v_cvt_pk_bf16_f32 v34, v20, v21
    v_cvt_pk_bf16_f32 v35, v22, v23
    v_and_b32 v32, -2, v32
    buffer_store_dwordx4 v[32:35], v1, s[8:11], s53 offen sc1
    v_and_b32 v6, 0x3ff, v90
    s_cmp_lt_u32 s3, 4
    s_cbranch_scc0 B_start
    v_add_u32 v7, 77824, v89
    s_lshl_b32 s48, s31, 13
    s_sub_u32 s48, s48, 0x1000
    v_lshlrev_b32 v8, 16, v120
    v_and_b32 v9, 0xffff0000, v120
    v_lshlrev_b32 v10, 16, v121
    v_and_b32 v11, 0xffff0000, v121
    v_lshlrev_b32 v12, 16, v122
    v_and_b32 v13, 0xffff0000, v122
    v_lshlrev_b32 v14, 16, v123
    v_and_b32 v15, 0xffff0000, v123
    v_lshlrev_b32 v16, 16, v124
    v_and_b32 v17, 0xffff0000, v124
    v_lshlrev_b32 v18, 16, v125
    v_and_b32 v19, 0xffff0000, v125
    v_lshlrev_b32 v20, 16, v126
    v_and_b32 v21, 0xffff0000, v126
    v_lshlrev_b32 v22, 16, v127
    v_and_b32 v23, 0xffff0000, v127
    s_add_u32 s58, s57, s36
    s_add_u32 s57, s58, 0x20000
    s_add_u32 s53, s54, 0x20000
    s_waitcnt vmcnt(0) lgkmcnt(0)
    s_barrier
    s_mov_b32 s47, 0
A1_again:
    s_mov_b32 s42, s58
    buffer_load_dwordx4 v[56:59], v1, s[8:11], s42 offen offset:0 sc1
    buffer_load_dwordx4 v[60:63], v1, s[8:11], s42 offen offset:1024 sc1
    buffer_load_dwordx4 v[64:67], v1, s[8:11], s42 offen offset:2048 sc1
    buffer_load_dwordx4 v[68:71], v1, s[8:11], s42 offen offset:3072 sc1
    s_add_u32 s42, s42, 4096
    buffer_load_dwordx4 v[72:75], v1, s[8:11], s42 offen offset:0 sc1
    buffer_load_dwordx4 v[76:79], v1, s[8:11], s42 offen offset:1024 sc1
    buffer_load_dwordx4 v[80:83], v1, s[8:11], s42 offen offset:2048 sc1
    buffer_load_dwordx4 v[84:87], v1, s[8:11], s42 offen offset:3072 sc1
    s_add_u32 s42, s42, 4096
    buffer_load_dwordx4 v[88:91], v1, s[8:11], s42 offen offset:0 sc1
    buffer_load_dwordx4 v[92:95], v1, s[8:11], s42 offen offset:1024 sc1
    buffer_load_dwordx4 v[96:99], v1, s[8:11], s42 offen offset:2048 sc1
    buffer_load_dwordx4 v[100:103], v1, s[8:11], s42 offen offset:3072 sc1
    s_add_u32 s42, s42, 4096
    buffer_load_dwordx4 v[104:107], v1, s[8:11], s42 offen offset:0 sc1
    buffer_load_dwordx4 v[108:111], v1, s[8:11], s42 offen offset:1024 sc1
    buffer_load_dwordx4 v[112:115], v1, s[8:11], s42 offen offset:2048 sc1
    buffer_load_dwordx4 v[116:119], v1, s[8:11], s42 offen offset:3072 sc1
    s_waitcnt vmcnt(15)
    v_mfma_f32_32x32x16_bf16 v[40:55], v[192:195], v[56:59], 0
    v_mfma_f32_32x32x16_bf16 v[24:39], v[128:131], v[56:59], v[8:23]
    s_waitcnt vmcnt(14)
    v_mfma_f32_32x32x16_bf16 v[40:55], v[196:199], v[60:63], v[40:55]
    v_mfma_f32_32x32x16_bf16 v[24:39], v[132:135], v[60:63], v[24:39]
    v_or3_b32 v2, v56, v60, 0
    s_waitcnt vmcnt(13)
    v_mfma_f32_32x32x16_bf16 v[40:55], v[200:203], v[64:67], v[40:55]
    v_mfma_f32_32x32x16_bf16 v[24:39], v[136:139], v[64:67], v[24:39]
    s_waitcnt vmcnt(12)
    v_mfma_f32_32x32x16_bf16 v[40:55], v[204:207], v[68:71], v[40:55]
    v_mfma_f32_32x32x16_bf16 v[24:39], v[140:143], v[68:71], v[24:39]
    v_or3_b32 v2, v64, v68, v2
    s_waitcnt vmcnt(11)
    v_mfma_f32_32x32x16_bf16 v[40:55], v[208:211], v[72:75], v[40:55]
    v_mfma_f32_32x32x16_bf16 v[24:39], v[144:147], v[72:75], v[24:39]
    s_waitcnt vmcnt(10)
    v_mfma_f32_32x32x16_bf16 v[40:55], v[212:215], v[76:79], v[40:55]
    v_mfma_f32_32x32x16_bf16 v[24:39], v[148:151], v[76:79], v[24:39]
    v_or3_b32 v2, v72, v76, v2
    s_waitcnt vmcnt(9)
    v_mfma_f32_32x32x16_bf16 v[40:55], v[216:219], v[80:83], v[40:55]
    v_mfma_f32_32x32x16_bf16 v[24:39], v[152:155], v[80:83], v[24:39]
    s_waitcnt vmcnt(8)
    v_mfma_f32_32x32x16_bf16 v[40:55], v[220:223], v[84:87], v[40:55]
    v_mfma_f32_32x32x16_bf16 v[24:39], v[156:159], v[84:87], v[24:39]
    v_or3_b32 v2, v80, v84, v2
    s_waitcnt vmcnt(7)
    v_mfma_f32_32x32x16_bf16 v[40:55], v[224:227], v[88:91], v[40:55]
    v_mfma_f32_32x32x16_bf16 v[24:39], v[160:163], v[88:91], v[24:39]
    s_waitcnt vmcnt(6)
    v_mfma_f32_32x32x16_bf16 v[40:55], v[228:231], v[92:95], v[40:55]
    v_mfma_f32_32x32x16_bf16 v[24:39], v[164:167], v[92:95], v[24:39]
    v_or3_b32 v2, v88, v92, v2
    s_waitcnt vmcnt(5)
    v_mfma_f32_32x32x16_bf16 v[40:55], v[232:235], v[96:99], v[40:55]
    v_mfma_f32_32x32x16_bf16 v[24:39], v[168:171], v[96:99], v[24:39]
    s_waitcnt vmcnt(4)
    v_mfma_f32_32x32x16_bf16 v[40:55], v[236:239], v[100:103], v[40:55]
    v_mfma_f32_32x32x16_bf16 v[24:39], v[172:175], v[100:103], v[24:39]
    v_or3_b32 v2, v96, v100, v2
    s_waitcnt vmcnt(3)
    v_mfma_f32_32x32x16_bf16 v[40:55], v[240:243], v[104:107], v[40:55]
    v_mfma_f32_32x32x16_bf16 v[24:39], v[176:179], v[104:107], v[24:39]
    s_waitcnt vmcnt(2)
    v_mfma_f32_32x32x16_bf16 v[40:55], v[244:247], v[108:111], v[40:55]
    v_mfma_f32_32x32x16_bf16 v[24:39], v[180:183], v[108:111], v[24:39]
    v_or3_b32 v2, v104, v108, v2
    s_waitcnt vmcnt(1)
    v_mfma_f32_32x32x16_bf16 v[40:55], v[248:251], v[112:115], v[40:55]
    v_mfma_f32_32x32x16_bf16 v[24:39], v[184:187], v[112:115], v[24:39]
    s_waitcnt vmcnt(0)
    v_mfma_f32_32x32x16_bf16 v[40:55], v[252:255], v[116:119], v[40:55]
    v_mfma_f32_32x32x16_bf16 v[24:39], v[188:191], v[116:119], v[24:39]
    v_or3_b32 v2, v112, v116, v2
    v_and_b32 v2, 1, v2
    v_cmp_ne_u32 vcc, 0, v2
    s_cbranch_vccz A1_ok
    s_cmp_eq_u32 s34, 0
    s_cbranch_scc1 A1_ok
    s_sub_u32 s34, s34, 1
    s_mov_b32 s47, 1
    s_sleep 2
    s_and_b32 s98, s34, 63
    s_cbranch_scc1 A1_again
    v_mov_b32 v2, s34
    buffer_store_dword v2, off, s[8:11], s96 sc1
    s_branch A1_again
A1_ok:
    s_nop 6
    ds_write_b128 v7, v[40:43] offset:0
    ds_write_b128 v7, v[44:47] offset:1024
    ds_write_b128 v7, v[48:51] offset:2048
    ds_write_b128 v7, v[52:55] offset:3072
    s_waitcnt lgkmcnt(0)
    s_barrier
    v_add_u32 v2, s48, v7
    ds_read_b128 v[40:43], v2 offset:0
    ds_read_b128 v[44:47], v2 offset:1024
    ds_read_b128 v[48:51], v2 offset:2048
    ds_read_b128 v[52:55], v2 offset:3072
    s_add_u32 s56, s55, 0x30000
    s_waitcnt lgkmcnt(0)
    v_pk_add_f32 v[24:25], v[24:25], v[40:41]
    v_pk_add_f32 v[26:27], v[26:27], v[42:43]
    v_pk_add_f32 v[28:29], v[28:29], v[44:45]
    v_pk_add_f32 v[30:31], v[30:31], v[46:47]
    v_pk_add_f32 v[32:33], v[32:33], v[48:49]
    v_pk_add_f32 v[34:35], v[34:35], v[50:51]
    v_pk_add_f32 v[36:37], v[36:37], v[52:53]
    v_pk_add_f32 v[38:39], v[38:39], v[54:55]
    v_cvt_pk_bf16_f32 v40, v24, v25
    v_cvt_pk_bf16_f32 v44, v32, v33
    v_add_u32_sdwa v40, v24, 1 dst_sel:WORD_0 dst_unused:UNUSED_PRESERVE src0_sel:WORD_1 src1_sel:DWORD
    v_add_u32_sdwa v44, v32, 1 dst_sel:WORD_0 dst_unused:UNUSED_PRESERVE src0_sel:WORD_1 src1_sel:DWORD
    v_cvt_pk_bf16_f32 v41, v26, v27
    v_cvt_pk_bf16_f32 v42, v28, v29
    v_cvt_pk_bf16_f32 v43, v30, v31
    v_cvt_pk_bf16_f32 v45, v34, v35
    v_cvt_pk_bf16_f32 v46, v36, v37
    v_cvt_pk_bf16_f32 v47, v38, v39
    v_and_b32 v40, -2, v40
    v_and_b32 v44, -2, v44
    buffer_store_dwordx4 v[40:43], v1, s[8:11], s53 offen sc1
    buffer_store_dwordx4 v[44:47], v1, s[8:11], s53 offen offset:1024 sc1
    v_pk_add_f32 v[60:61], v[24:25], v[26:27]
    v_pk_mul_f32 v[62:63], v[24:25], v[24:25]
    v_pk_fma_f32 v[62:63], v[26:27], v[26:27], v[62:63]
    v_pk_add_f32 v[60:61], v[60:61], v[28:29]
    v_pk_fma_f32 v[62:63], v[28:29], v[28:29], v[62:63]
    v_pk_add_f32 v[60:61], v[60:61], v[30:31]
    v_pk_fma_f32 v[62:63], v[30:31], v[30:31], v[62:63]
    v_pk_add_f32 v[60:61], v[60:61], v[32:33]
    v_pk_fma_f32 v[62:63], v[32:33], v[32:33], v[62:63]
    v_pk_add_f32 v[60:61], v[60:61], v[34:35]
    v_pk_fma_f32 v[62:63], v[34:35], v[34:35], v[62:63]
    v_pk_add_f32 v[60:61], v[60:61], v[36:37]
    v_pk_fma_f32 v[62:63], v[36:37], v[36:37], v[62:63]
    v_pk_add_f32 v[60:61], v[60:61], v[38:39]
    v_pk_fma_f32 v[62:63], v[38:39], v[38:39], v[62:63]
    v_add_f32 v60, v60, v61
    v_add_f32 v62, v62, v63
    v_lshlrev_b32 v61, 3, v3
    v_lshl_add_u32 v61, v4, 2, v61
    v_permlane32_swap_b32 v60, v62
    v_add_f32 v60, v60, v62
    v_and_b32 v60, -2, v60
    buffer_store_dword v60, v61, s[8:11], s56 offen sc1
    v_cvt_pk_bf16_f32 v120, v24, v25
    v_cvt_pk_bf16_f32 v121, v26, v27
    v_cvt_pk_bf16_f32 v122, v28, v29
    v_cvt_pk_bf16_f32 v123, v30, v31
    v_cvt_pk_bf16_f32 v124, v32, v33
    v_cvt_pk_bf16_f32 v125, v34, v35
    v_cvt_pk_bf16_f32 v126, v36, v37
    v_cvt_pk_bf16_f32 v127, v38, v39
    s_lshl_b32 s42, s31, 15
    s_add_u32 s42, s42, 98304
    v_add_u32 v2, s42, v6
    v_xor_b32 v56, 64, v2
    ds_read_b64_tr_b16 v[192:193], v56 offset:0
    ds_read_b64_tr_b16 v[194:195], v56 offset:1024
    ds_read_b64_tr_b16 v[128:129], v2 offset:0
    ds_read_b64_tr_b16 v[130:131], v2 offset:1024
    ds_read_b64_tr_b16 v[196:197], v56 offset:2048
    ds_read_b64_tr_b16 v[198:199], v56 offset:3072
    ds_read_b64_tr_b16 v[132:133], v2 offset:2048
    ds_read_b64_tr_b16 v[134:135], v2 offset:3072
    ds_read_b64_tr_b16 v[200:201], v56 offset:4096
    ds_read_b64_tr_b16 v[202:203], v56 offset:5120
    ds_read_b64_tr_b16 v[136:137], v2 offset:4096
    ds_read_b64_tr_b16 v[138:139], v2 offset:5120
    ds_read_b64_tr_b16 v[204:205], v56 offset:6144
    ds_read_b64_tr_b16 v[206:207], v56 offset:7168
    ds_read_b64_tr_b16 v[140:141], v2 offset:6144
    ds_read_b64_tr_b16 v[142:143], v2 offset:7168
    ds_read_b64_tr_b16 v[208:209], v56 offset:8192
    ds_read_b64_tr_b16 v[210:211], v56 offset:9216
    ds_read_b64_tr_b16 v[144:145], v2 offset:8192
    ds_read_b64_tr_b16 v[146:147], v2 offset:9216
    ds_read_b64_tr_b16 v[212:213], v56 offset:10240
    ds_read_b64_tr_b16 v[214:215], v56 offset:11264
    ds_read_b64_tr_b16 v[148:149], v2 offset:10240
    ds_read_b64_tr_b16 v[150:151], v2 offset:11264
    ds_read_b64_tr_b16 v[216:217], v56 offset:12288
    ds_read_b64_tr_b16 v[218:219], v56 offset:13312
    ds_read_b64_tr_b16 v[152:153], v2 offset:12288
    ds_read_b64_tr_b16 v[154:155], v2 offset:13312
    ds_read_b64_tr_b16 v[220:221], v56 offset:14336
    ds_read_b64_tr_b16 v[222:223], v56 offset:15360
    ds_read_b64_tr_b16 v[156:157], v2 offset:14336
    ds_read_b64_tr_b16 v[158:159], v2 offset:15360
    ds_read_b64_tr_b16 v[224:225], v56 offset:16384
    ds_read_b64_tr_b16 v[226:227], v56 offset:17408
    ds_read_b64_tr_b16 v[160:161], v2 offset:16384
    ds_read_b64_tr_b16 v[162:163], v2 offset:17408
    ds_read_b64_tr_b16 v[228:229], v56 offset:18432
    ds_read_b64_tr_b16 v[230:231], v56 offset:19456
    ds_read_b64_tr_b16 v[164:165], v2 offset:18432
    ds_read_b64_tr_b16 v[166:167], v2 offset:19456
    ds_read_b64_tr_b16 v[232:233], v56 offset:20480
    ds_read_b64_tr_b16 v[234:235], v56 offset:21504
    ds_read_b64_tr_b16 v[168:169], v2 offset:20480
    ds_read_b64_tr_b16 v[170:171], v2 offset:21504
    ds_read_b64_tr_b16 v[236:237], v56 offset:22528
    ds_read_b64_tr_b16 v[238:239], v56 offset:23552
    ds_read_b64_tr_b16 v[172:173], v2 offset:22528
    ds_read_b64_tr_b16 v[174:175], v2 offset:23552
    ds_read_b64_tr_b16 v[240:241], v56 offset:24576
    ds_read_b64_tr_b16 v[242:243], v56 offset:25600
    ds_read_b64_tr_b16 v[176:177], v2 offset:24576
    ds_read_b64_tr_b16 v[178:179], v2 offset:25600
    ds_read_b64_tr_b16 v[244:245], v56 offset:26624
    ds_read_b64_tr_b16 v[246:247], v56 offset:27648
    ds_read_b64_tr_b16 v[180:181], v2 offset:26624
    ds_read_b64_tr_b16 v[182:183], v2 offset:27648
    ds_read_b64_tr_b16 v[248:249], v56 offset:28672
    ds_read_b64_tr_b16 v[250:251], v56 offset:29696
    ds_read_b64_tr_b16 v[184:185], v2 offset:28672
    ds_read_b64_tr_b16 v[186:187], v2 offset:29696
    ds_read_b64_tr_b16 v[252:253], v56 offset:30720
    ds_read_b64_tr_b16 v[254:255], v56 offset:31744
    ds_read_b64_tr_b16 v[188:189], v2 offset:30720
    ds_read_b64_tr_b16 v[190:191], v2 offset:31744
    s_waitcnt vmcnt(0) lgkmcnt(0)
    s_mov_b32 s47, 0
A2_again:
    s_mov_b32 s42, s57
    buffer_load_dwordx4 v[56:59], v1, s[8:11], s42 offen offset:0 sc1
    buffer_load_dwordx4 v[60:63], v1, s[8:11], s42 offen offset:1024 sc1
    buffer_load_dwordx4 v[64:67], v1, s[8:11], s42 offen offset:2048 sc1
    buffer_load_dwordx4 v[68:71], v1, s[8:11], s42 offen offset:3072 sc1
    s_add_u32 s42, s42, 4096
    buffer_load_dwordx4 v[72:75], v1, s[8:11], s42 offen offset:0 sc1
    buffer_load_dwordx4 v[76:79], v1, s[8:11], s42 offen offset:1024 sc1
    buffer_load_dwordx4 v[80:83], v1, s[8:11], s42 offen offset:2048 sc1
    buffer_load_dwordx4 v[84:87], v1, s[8:11], s42 offen offset:3072 sc1
    s_add_u32 s42, s42, 4096
    buffer_load_dwordx4 v[88:91], v1, s[8:11], s42 offen offset:0 sc1
    buffer_load_dwordx4 v[92:95], v1, s[8:11], s42 offen offset:1024 sc1
    buffer_load_dwordx4 v[96:99], v1, s[8:11], s42 offen offset:2048 sc1
    buffer_load_dwordx4 v[100:103], v1, s[8:11], s42 offen offset:3072 sc1
    s_add_u32 s42, s42, 4096
    buffer_load_dwordx4 v[104:107], v1, s[8:11], s42 offen offset:0 sc1
    buffer_load_dwordx4 v[108:111], v1, s[8:11], s42 offen offset:1024 sc1
    buffer_load_dwordx4 v[112:115], v1, s[8:11], s42 offen offset:2048 sc1
    buffer_load_dwordx4 v[116:119], v1, s[8:11], s42 offen offset:3072 sc1
    s_add_u32 s56, s54, 0x10000
    s_lshr_b32 s42, s28, 3
    s_lshl_b32 s42, s42, 15
    s_and_b32 s43, s28, 7
    s_lshl_b32 s43, s43, 7
    s_add_u32 s42, s42, s43
    s_lshl_b32 s43, s30, 12
    s_add_u32 s42, s42, s43
    s_lshl_b32 s43, s31, 11
    s_add_u32 s42, s42, s43
    s_add_u32 s43, s42, 0x900000
    s_bfe_u32 s42, s30, 0x10001
    s_cmp_lg_u32 s42, s35
    s_cselect_b32 s43, s43, 0x40000000
    s_cmp_eq_u32 s35, 0
    s_cselect_b32 s40, 3, 0xc0000000
    s_mov_b32 s41, s40
    v_and_b32 v0, 1, v3
    v_lshlrev_b32 v0, 5, v0
    v_lshl_add_u32 v0, v4, 4, v0
    s_lshl_b32 s42, s35, 9
    s_add_u32 s42, s42, 95232
    v_lshl_add_u32 v5, v3, 4, s42
    s_cmp_lg_u32 s47, 0
    s_cbranch_scc1 A2_nb
    s_barrier
A2_nb:
    s_waitcnt vmcnt(15)
    v_mfma_f32_32x32x16_bf16 v[40:55], v[192:195], v[56:59], 0
    v_mfma_f32_32x32x16_bf16 v[24:39], v[128:131], v[56:59], 0
    s_waitcnt vmcnt(14)
    v_mfma_f32_32x32x16_bf16 v[40:55], v[196:199], v[60:63], v[40:55]
    v_mfma_f32_32x32x16_bf16 v[24:39], v[132:135], v[60:63], v[24:39]
    v_or3_b32 v2, v56, v60, 0
    s_waitcnt vmcnt(13)
    v_mfma_f32_32x32x16_bf16 v[40:55], v[200:203], v[64:67], v[40:55]
    v_mfma_f32_32x32x16_bf16 v[24:39], v[136:139], v[64:67], v[24:39]
    s_waitcnt vmcnt(12)
    v_mfma_f32_32x32x16_bf16 v[40:55], v[204:207], v[68:71], v[40:55]
    v_mfma_f32_32x32x16_bf16 v[24:39], v[140:143], v[68:71], v[24:39]
    v_or3_b32 v2, v64, v68, v2
    s_waitcnt vmcnt(11)
    v_mfma_f32_32x32x16_bf16 v[40:55], v[208:211], v[72:75], v[40:55]
    v_mfma_f32_32x32x16_bf16 v[24:39], v[144:147], v[72:75], v[24:39]
    s_waitcnt vmcnt(10)
    v_mfma_f32_32x32x16_bf16 v[40:55], v[212:215], v[76:79], v[40:55]
    v_mfma_f32_32x32x16_bf16 v[24:39], v[148:151], v[76:79], v[24:39]
    v_or3_b32 v2, v72, v76, v2
    s_waitcnt vmcnt(9)
    v_mfma_f32_32x32x16_bf16 v[40:55], v[216:219], v[80:83], v[40:55]
    v_mfma_f32_32x32x16_bf16 v[24:39], v[152:155], v[80:83], v[24:39]
    s_waitcnt vmcnt(8)
    v_mfma_f32_32x32x16_bf16 v[40:55], v[220:223], v[84:87], v[40:55]
    v_mfma_f32_32x32x16_bf16 v[24:39], v[156:159], v[84:87], v[24:39]
    v_or3_b32 v2, v80, v84, v2
    s_waitcnt vmcnt(7)
    v_mfma_f32_32x32x16_bf16 v[40:55], v[224:227], v[88:91], v[40:55]
    v_mfma_f32_32x32x16_bf16 v[24:39], v[160:163], v[88:91], v[24:39]
    s_waitcnt vmcnt(6)
    v_mfma_f32_32x32x16_bf16 v[40:55], v[228:231], v[92:95], v[40:55]
    v_mfma_f32_32x32x16_bf16 v[24:39], v[164:167], v[92:95], v[24:39]
    v_or3_b32 v2, v88, v92, v2
    s_waitcnt vmcnt(5)
    v_mfma_f32_32x32x16_bf16 v[40:55], v[232:235], v[96:99], v[40:55]
    v_mfma_f32_32x32x16_bf16 v[24:39], v[168:171], v[96:99], v[24:39]
    s_waitcnt vmcnt(4)
    v_mfma_f32_32x32x16_bf16 v[40:55], v[236:239], v[100:103], v[40:55]
    v_mfma_f32_32x32x16_bf16 v[24:39], v[172:175], v[100:103], v[24:39]
    v_or3_b32 v2, v96, v100, v2
    s_waitcnt vmcnt(3)
    v_mfma_f32_32x32x16_bf16 v[40:55], v[240:243], v[104:107], v[40:55]
    v_mfma_f32_32x32x16_bf16 v[24:39], v[176:179], v[104:107], v[24:39]
    s_waitcnt vmcnt(2)
    v_mfma_f32_32x32x16_bf16 v[40:55], v[244:247], v[108:111], v[40:55]
    v_mfma_f32_32x32x16_bf16 v[24:39], v[180:183], v[108:111], v[24:39]
    v_or3_b32 v2, v104, v108, v2
    s_waitcnt vmcnt(1)
    v_mfma_f32_32x32x16_bf16 v[40:55], v[248:251], v[112:115], v[40:55]
    v_mfma_f32_32x32x16_bf16 v[24:39], v[184:187], v[112:115], v[24:39]
    s_waitcnt vmcnt(0)
    v_mfma_f32_32x32x16_bf16 v[40:55], v[252:255], v[116:119], v[40:55]
    v_mfma_f32_32x32x16_bf16 v[24:39], v[188:191], v[116:119], v[24:39]
    v_or3_b32 v2, v112, v116, v2
    v_and_b32 v2, 1, v2
    v_cmp_ne_u32 vcc, 0, v2
    s_cbranch_vccz A2_ok
    s_cmp_eq_u32 s34, 0
    s_cbranch_scc1 A2_ok
    s_sub_u32 s34, s34, 1
    s_mov_b32 s47, 1
    s_sleep 2
    s_and_b32 s98, s34, 63
    s_cbranch_scc1 A2_again
    v_mov_b32 v2, s34
    buffer_store_dword v2, off, s[8:11], s96 sc1
    s_branch A2_again
A2_ok:
    s_nop 6
    ds_write_b128 v7, v[40:43] offset:0
    ds_write_b128 v7, v[44:47] offset:1024
    ds_write_b128 v7, v[48:51] offset:2048
    ds_write_b128 v7, v[52:55] offset:3072
    s_lshl_b32 s42, s31, 7
    s_add_u32 s42, s42, 94208
    v_lshl_add_u32 v2, v4, 4, s42
    ds_read_b128 v[88:91], v2 offset:0
    ds_read_b128 v[92:95], v2 offset:32
    ds_read_b128 v[96:99], v2 offset:64
    ds_read_b128 v[100:103], v2 offset:96
    s_waitcnt lgkmcnt(0)
    s_barrier
    ds_read_b128 v[8:11], v5
    v_add_u32 v2, s48, v7
    ds_read_b128 v[40:43], v2 offset:0
    ds_read_b128 v[44:47], v2 offset:1024
    ds_read_b128 v[48:51], v2 offset:2048
    ds_read_b128 v[52:55], v2 offset:3072
    s_waitcnt lgkmcnt(4)
    v_pk_mul_f32 v[88:89], v[88:89], v[8:9] op_sel:[0,1] op_sel_hi:[1,1]
    v_pk_mul_f32 v[90:91], v[90:91], v[8:9] op_sel:[0,1] op_sel_hi:[1,1]
    v_pk_mul_f32 v[92:93], v[92:93], v[8:9] op_sel:[0,1] op_sel_hi:[1,1]
    v_pk_mul_f32 v[94:95], v[94:95], v[8:9] op_sel:[0,1] op_sel_hi:[1,1]
    v_pk_mul_f32 v[96:97], v[96:97], v[8:9] op_sel:[0,1] op_sel_hi:[1,1]
    v_pk_mul_f32 v[98:99], v[98:99], v[8:9] op_sel:[0,1] op_sel_hi:[1,1]
    v_pk_mul_f32 v[100:101], v[100:101], v[8:9] op_sel:[0,1] op_sel_hi:[1,1]
    v_pk_mul_f32 v[102:103], v[102:103], v[8:9] op_sel:[0,1] op_sel_hi:[1,1]
    s_waitcnt lgkmcnt(0)
    v_pk_add_f32 v[24:25], v[24:25], v[40:41]
    v_pk_add_f32 v[26:27], v[26:27], v[42:43]
    v_pk_add_f32 v[28:29], v[28:29], v[44:45]
    v_pk_add_f32 v[30:31], v[30:31], v[46:47]
    v_pk_add_f32 v[32:33], v[32:33], v[48:49]
    v_pk_add_f32 v[34:35], v[34:35], v[50:51]
    v_pk_add_f32 v[36:37], v[36:37], v[52:53]
    v_pk_add_f32 v[38:39], v[38:39], v[54:55]
    v_pk_fma_f32 v[24:25], v[24:25], v[8:9], v[88:89] op_sel_hi:[1,0,1]
    v_pk_fma_f32 v[26:27], v[26:27], v[8:9], v[90:91] op_sel_hi:[1,0,1]
    v_pk_fma_f32 v[28:29], v[28:29], v[8:9], v[92:93] op_sel_hi:[1,0,1]
    v_pk_fma_f32 v[30:31], v[30:31], v[8:9], v[94:95] op_sel_hi:[1,0,1]
    v_pk_fma_f32 v[32:33], v[32:33], v[8:9], v[96:97] op_sel_hi:[1,0,1]
    v_pk_fma_f32 v[34:35], v[34:35], v[8:9], v[98:99] op_sel_hi:[1,0,1]
    v_pk_fma_f32 v[36:37], v[36:37], v[8:9], v[100:101] op_sel_hi:[1,0,1]
    v_pk_fma_f32 v[38:39], v[38:39], v[8:9], v[102:103] op_sel_hi:[1,0,1]
    v_mov_b32 v118, 0xc0135761
    v_mov_b32 v119, 0xc0135761
    v_pk_mul_f32 v[60:61], v[24:25], v[24:25]
    v_pk_mul_f32 v[62:63], v[26:27], v[26:27]
    v_pk_mul_f32 v[64:65], v[28:29], v[28:29]
    v_pk_mul_f32 v[66:67], v[30:31], v[30:31]
    v_pk_mul_f32 v[68:69], v[32:33], v[32:33]
    v_pk_mul_f32 v[70:71], v[34:35], v[34:35]
    v_pk_mul_f32 v[72:73], v[36:37], v[36:37]
    v_pk_mul_f32 v[74:75], v[38:39], v[38:39]
    v_pk_fma_f32 v[60:61], v[60:61], s[44:45], v[118:119]
    v_pk_fma_f32 v[62:63], v[62:63], s[44:45], v[118:119]
    v_pk_fma_f32 v[64:65], v[64:65], s[44:45], v[118:119]
    v_pk_fma_f32 v[66:67], v[66:67], s[44:45], v[118:119]
    v_pk_fma_f32 v[68:69], v[68:69], s[44:45], v[118:119]
    v_pk_fma_f32 v[70:71], v[70:71], s[44:45], v[118:119]
    v_pk_fma_f32 v[72:73], v[72:73], s[44:45], v[118:119]
    v_pk_fma_f32 v[74:75], v[74:75], s[44:45], v[118:119]
    v_pk_mul_f32 v[60:61], v[60:61], v[24:25]
    v_pk_mul_f32 v[62:63], v[62:63], v[26:27]
    v_pk_mul_f32 v[64:65], v[64:65], v[28:29]
    v_pk_mul_f32 v[66:67], v[66:67], v[30:31]
    v_pk_mul_f32 v[68:69], v[68:69], v[32:33]
    v_pk_mul_f32 v[70:71], v[70:71], v[34:35]
    v_pk_mul_f32 v[72:73], v[72:73], v[36:37]
    v_pk_mul_f32 v[74:75], v[74:75], v[38:39]
    v_exp_f32 v60, v60
    v_exp_f32 v61, v61
    v_exp_f32 v62, v62
    v_exp_f32 v63, v63
    v_exp_f32 v64, v64
    v_exp_f32 v65, v65
    v_exp_f32 v66, v66
    v_exp_f32 v67, v67
    v_exp_f32 v68, v68
    v_exp_f32 v69, v69
    v_exp_f32 v70, v70
    v_exp_f32 v71, v71
    v_exp_f32 v72, v72
    v_exp_f32 v73, v73
    v_exp_f32 v74, v74
    v_exp_f32 v75, v75
    v_pk_add_f32 v[60:61], v[60:61], 1.0 op_sel_hi:[1,0]
    v_pk_add_f32 v[62:63], v[62:63], 1.0 op_sel_hi:[1,0]
    v_pk_add_f32 v[64:65], v[64:65], 1.0 op_sel_hi:[1,0]
    v_pk_add_f32 v[66:67], v[66:67], 1.0 op_sel_hi:[1,0]
    v_pk_add_f32 v[68:69], v[68:69], 1.0 op_sel_hi:[1,0]
    v_pk_add_f32 v[70:71], v[70:71], 1.0 op_sel_hi:[1,0]
    v_pk_add_f32 v[72:73], v[72:73], 1.0 op_sel_hi:[1,0]
    v_pk_add_f32 v[74:75], v[74:75], 1.0 op_sel_hi:[1,0]
    v_rcp_f32 v60, v60
    v_rcp_f32 v61, v61
    v_rcp_f32 v62, v62
    v_rcp_f32 v63, v63
    v_rcp_f32 v64, v64
    v_rcp_f32 v65, v65
    v_rcp_f32 v66, v66
    v_rcp_f32 v67, v67
    v_rcp_f32 v68, v68
    v_rcp_f32 v69, v69
    v_rcp_f32 v70, v70
    v_rcp_f32 v71, v71
    v_rcp_f32 v72, v72
    v_rcp_f32 v73, v73
    v_rcp_f32 v74, v74
    v_rcp_f32 v75, v75
    v_pk_mul_f32 v[24:25], v[24:25], v[60:61]
    v_pk_mul_f32 v[26:27], v[26:27], v[62:63]
    v_pk_mul_f32 v[28:29], v[28:29], v[64:65]
    v_pk_mul_f32 v[30:31], v[30:31], v[66:67]
    v_pk_mul_f32 v[32:33], v[32:33], v[68:69]
    v_pk_mul_f32 v[34:35], v[34:35], v[70:71]
    v_pk_mul_f32 v[36:37], v[36:37], v[72:73]
    v_pk_mul_f32 v[38:39], v[38:39], v[74:75]
    v_cvt_pk_bf16_f32 v40, v24, v25
    v_cvt_pk_bf16_f32 v44, v32, v33
    v_add_u32_sdwa v40, v24, 1 dst_sel:WORD_0 dst_unused:UNUSED_PRESERVE src0_sel:WORD_1 src1_sel:DWORD
    v_add_u32_sdwa v44, v32, 1 dst_sel:WORD_0 dst_unused:UNUSED_PRESERVE src0_sel:WORD_1 src1_sel:DWORD
    v_cvt_pk_bf16_f32 v41, v26, v27
    v_cvt_pk_bf16_f32 v42, v28, v29
    v_cvt_pk_bf16_f32 v43, v30, v31
    v_cvt_pk_bf16_f32 v45, v34, v35
    v_cvt_pk_bf16_f32 v46, v36, v37
    v_cvt_pk_bf16_f32 v47, v38, v39
    v_and_b32 v40, -2, v40
    v_and_b32 v44, -2, v44
    buffer_store_dwordx4 v[40:43], v1, s[8:11], s56 offen sc1
    buffer_store_dwordx4 v[44:47], v1, s[8:11], s56 offen offset:1024 sc1
    s_mov_b64 exec, s[40:41]
    buffer_store_dwordx4 v[40:43], v0, s[8:11], s43 offen sc1
    buffer_store_dwordx4 v[44:47], v0, s[8:11], s43 offen offset:1024 sc1
    s_mov_b64 exec, -1
    s_barrier
    s_lshl_b32 s42, s31, 15
    s_add_u32 s42, s42, 0
    v_add_u32 v2, s42, v6
    v_xor_b32 v56, 64, v2
    ds_read_b64_tr_b16 v[192:193], v56 offset:0
    ds_read_b64_tr_b16 v[194:195], v56 offset:1024
    ds_read_b64_tr_b16 v[128:129], v2 offset:0
    ds_read_b64_tr_b16 v[130:131], v2 offset:1024
    ds_read_b64_tr_b16 v[196:197], v56 offset:2048
    ds_read_b64_tr_b16 v[198:199], v56 offset:3072
    ds_read_b64_tr_b16 v[132:133], v2 offset:2048
    ds_read_b64_tr_b16 v[134:135], v2 offset:3072
    ds_read_b64_tr_b16 v[200:201], v56 offset:4096
    ds_read_b64_tr_b16 v[202:203], v56 offset:5120
    ds_read_b64_tr_b16 v[136:137], v2 offset:4096
    ds_read_b64_tr_b16 v[138:139], v2 offset:5120
    ds_read_b64_tr_b16 v[204:205], v56 offset:6144
    ds_read_b64_tr_b16 v[206:207], v56 offset:7168
    ds_read_b64_tr_b16 v[140:141], v2 offset:6144
    ds_read_b64_tr_b16 v[142:143], v2 offset:7168
    ds_read_b64_tr_b16 v[208:209], v56 offset:8192
    ds_read_b64_tr_b16 v[210:211], v56 offset:9216
    ds_read_b64_tr_b16 v[144:145], v2 offset:8192
    ds_read_b64_tr_b16 v[146:147], v2 offset:9216
    ds_read_b64_tr_b16 v[212:213], v56 offset:10240
    ds_read_b64_tr_b16 v[214:215], v56 offset:11264
    ds_read_b64_tr_b16 v[148:149], v2 offset:10240
    ds_read_b64_tr_b16 v[150:151], v2 offset:11264
    ds_read_b64_tr_b16 v[216:217], v56 offset:12288
    ds_read_b64_tr_b16 v[218:219], v56 offset:13312
    ds_read_b64_tr_b16 v[152:153], v2 offset:12288
    ds_read_b64_tr_b16 v[154:155], v2 offset:13312
    ds_read_b64_tr_b16 v[220:221], v56 offset:14336
    ds_read_b64_tr_b16 v[222:223], v56 offset:15360
    ds_read_b64_tr_b16 v[156:157], v2 offset:14336
    ds_read_b64_tr_b16 v[158:159], v2 offset:15360
    ds_read_b64_tr_b16 v[224:225], v56 offset:16384
    ds_read_b64_tr_b16 v[226:227], v56 offset:17408
    ds_read_b64_tr_b16 v[160:161], v2 offset:16384
    ds_read_b64_tr_b16 v[162:163], v2 offset:17408
    ds_read_b64_tr_b16 v[228:229], v56 offset:18432
    ds_read_b64_tr_b16 v[230:231], v56 offset:19456
    ds_read_b64_tr_b16 v[164:165], v2 offset:18432
    ds_read_b64_tr_b16 v[166:167], v2 offset:19456
    ds_read_b64_tr_b16 v[232:233], v56 offset:20480
    ds_read_b64_tr_b16 v[234:235], v56 offset:21504
    ds_read_b64_tr_b16 v[168:169], v2 offset:20480
    ds_read_b64_tr_b16 v[170:171], v2 offset:21504
    ds_read_b64_tr_b16 v[236:237], v56 offset:22528
    ds_read_b64_tr_b16 v[238:239], v56 offset:23552
    ds_read_b64_tr_b16 v[172:173], v2 offset:22528
    ds_read_b64_tr_b16 v[174:175], v2 offset:23552
    ds_read_b64_tr_b16 v[240:241], v56 offset:24576
    ds_read_b64_tr_b16 v[242:243], v56 offset:25600
    ds_read_b64_tr_b16 v[176:177], v2 offset:24576
    ds_read_b64_tr_b16 v[178:179], v2 offset:25600
    ds_read_b64_tr_b16 v[244:245], v56 offset:26624
    ds_read_b64_tr_b16 v[246:247], v56 offset:27648
    ds_read_b64_tr_b16 v[180:181], v2 offset:26624
    ds_read_b64_tr_b16 v[182:183], v2 offset:27648
    ds_read_b64_tr_b16 v[248:249], v56 offset:28672
    ds_read_b64_tr_b16 v[250:251], v56 offset:29696
    ds_read_b64_tr_b16 v[184:185], v2 offset:28672
    ds_read_b64_tr_b16 v[186:187], v2 offset:29696
    ds_read_b64_tr_b16 v[252:253], v56 offset:30720
    ds_read_b64_tr_b16 v[254:255], v56 offset:31744
    ds_read_b64_tr_b16 v[188:189], v2 offset:30720
    ds_read_b64_tr_b16 v[190:191], v2 offset:31744
    v_mov_b32 v24, v10
    v_mov_b32 v26, v11
    v_lshlrev_b32 v8, 16, v120
    v_and_b32 v9, 0xffff0000, v120
    v_lshlrev_b32 v10, 16, v121
    v_and_b32 v11, 0xffff0000, v121
    v_lshlrev_b32 v12, 16, v122
    v_and_b32 v13, 0xffff0000, v122
    v_lshlrev_b32 v14, 16, v123
    v_and_b32 v15, 0xffff0000, v123
    v_lshlrev_b32 v16, 16, v124
    v_and_b32 v17, 0xffff0000, v124
    v_lshlrev_b32 v18, 16, v125
    v_and_b32 v19, 0xffff0000, v125
    v_lshlrev_b32 v20, 16, v126
    v_and_b32 v21, 0xffff0000, v126
    v_lshlrev_b32 v22, 16, v127
    v_and_b32 v23, 0xffff0000, v127
    v_pk_fma_f32 v[8:9], v[8:9], v[24:25], v[26:27] op_sel_hi:[1,0,0]
    v_pk_fma_f32 v[10:11], v[10:11], v[24:25], v[26:27] op_sel_hi:[1,0,0]
    v_pk_fma_f32 v[12:13], v[12:13], v[24:25], v[26:27] op_sel_hi:[1,0,0]
    v_pk_fma_f32 v[14:15], v[14:15], v[24:25], v[26:27] op_sel_hi:[1,0,0]
    v_pk_fma_f32 v[16:17], v[16:17], v[24:25], v[26:27] op_sel_hi:[1,0,0]
    v_pk_fma_f32 v[18:19], v[18:19], v[24:25], v[26:27] op_sel_hi:[1,0,0]
    v_pk_fma_f32 v[20:21], v[20:21], v[24:25], v[26:27] op_sel_hi:[1,0,0]
    v_pk_fma_f32 v[22:23], v[22:23], v[24:25], v[26:27] op_sel_hi:[1,0,0]
    s_add_u32 s42, s31, 1
    s_lshl_b32 s43, s35, 5
    s_sub_u32 s43, s43, s42
    v_add_u32 v24, s43, v3
    v_lshrrev_b32 v25, 5, v24
    v_lshlrev_b32 v25, 15, v25
    v_and_b32 v26, 31, v24
    v_lshl_add_u32 v26, v4, 5, v26
    v_lshl_add_u32 v25, v26, 4, v25
    s_sub_u32 s42, s28, 1
    s_lshr_b32 s43, s42, 3
    s_lshl_b32 s43, s43, 15
    s_and_b32 s40, s42, 7
    s_lshl_b32 s40, s40, 7
    s_add_u32 s43, s43, s40
    s_add_u32 s43, s43, 0x8f0000
    s_sub_u32 s43, s43, s36
    s_cmp_lt_u32 s42, 32
    s_cselect_b32 s43, s43, 0x40000000
    v_and_b32 v26, 1, v24
    v_lshlrev_b32 v26, 5, v26
    v_lshl_add_u32 v26, v4, 4, v26
    v_add_u32 v26, s43, v26
    v_cmp_gt_u32 vcc, 64, v24
    s_nop 1
    v_cndmask_b32 v0, v26, v25, vcc
    s_add_u32 s42, s31, 1
    s_lshl_b32 s43, s35, 5
    s_add_u32 s43, s43, s42
    v_add_u32 v24, s43, v3
    v_lshrrev_b32 v25, 5, v24
    v_lshlrev_b32 v25, 15, v25
    v_and_b32 v26, 31, v24
    v_lshl_add_u32 v26, v4, 5, v26
    v_lshl_add_u32 v25, v26, 4, v25
    s_add_u32 s42, s28, 1
    s_lshr_b32 s43, s42, 3
    s_lshl_b32 s43, s43, 15
    s_and_b32 s40, s42, 7
    s_lshl_b32 s40, s40, 7
    s_add_u32 s43, s43, s40
    s_add_u32 s43, s43, 0x8f0000
    s_sub_u32 s43, s43, s36
    s_cmp_lt_u32 s42, 32
    s_cselect_b32 s43, s43, 0x40000000
    v_and_b32 v26, 1, v24
    v_lshlrev_b32 v26, 5, v26
    v_lshl_add_u32 v26, v4, 4, v26
    v_add_u32 v26, s43, v26
    v_cmp_gt_u32 vcc, 64, v24
    s_nop 1
    v_cndmask_b32 v5, v26, v25, vcc
    s_lshl_b32 s58, s31, 14
    s_add_u32 s58, s58, s36
    s_add_u32 s58, s58, 0x10000
    s_waitcnt vmcnt(0) lgkmcnt(0)
    s_mov_b32 s47, 0
A3_again:
    s_mov_b32 s42, s58
    buffer_load_dwordx4 v[56:59], v0, s[8:11], s42 offen offset:0 sc1
    buffer_load_dwordx4 v[60:63], v0, s[8:11], s42 offen offset:1024 sc1
    buffer_load_dwordx4 v[64:67], v0, s[8:11], s42 offen offset:2048 sc1
    buffer_load_dwordx4 v[68:71], v0, s[8:11], s42 offen offset:3072 sc1
    s_add_u32 s42, s42, 4096
    buffer_load_dwordx4 v[72:75], v0, s[8:11], s42 offen offset:0 sc1
    buffer_load_dwordx4 v[76:79], v0, s[8:11], s42 offen offset:1024 sc1
    buffer_load_dwordx4 v[80:83], v0, s[8:11], s42 offen offset:2048 sc1
    buffer_load_dwordx4 v[84:87], v0, s[8:11], s42 offen offset:3072 sc1
    s_add_u32 s42, s42, 4096
    buffer_load_dwordx4 v[88:91], v5, s[8:11], s42 offen offset:0 sc1
    buffer_load_dwordx4 v[92:95], v5, s[8:11], s42 offen offset:1024 sc1
    buffer_load_dwordx4 v[96:99], v5, s[8:11], s42 offen offset:2048 sc1
    buffer_load_dwordx4 v[100:103], v5, s[8:11], s42 offen offset:3072 sc1
    s_add_u32 s42, s42, 4096
    buffer_load_dwordx4 v[104:107], v5, s[8:11], s42 offen offset:0 sc1
    buffer_load_dwordx4 v[108:111], v5, s[8:11], s42 offen offset:1024 sc1
    buffer_load_dwordx4 v[112:115], v5, s[8:11], s42 offen offset:2048 sc1
    buffer_load_dwordx4 v[116:119], v5, s[8:11], s42 offen offset:3072 sc1
    s_cmp_lg_u32 s47, 0
    s_cbranch_scc1 A3_nb
    s_barrier
A3_nb:
    s_waitcnt vmcnt(15)
    v_mfma_f32_32x32x16_bf16 v[40:55], v[192:195], v[56:59], 0
    v_mfma_f32_32x32x16_bf16 v[24:39], v[128:131], v[56:59], v[8:23]
    s_waitcnt vmcnt(14)
    v_mfma_f32_32x32x16_bf16 v[40:55], v[196:199], v[60:63], v[40:55]
    v_mfma_f32_32x32x16_bf16 v[24:39], v[132:135], v[60:63], v[24:39]
    v_or3_b32 v2, v56, v60, 0
    s_waitcnt vmcnt(13)
    v_mfma_f32_32x32x16_bf16 v[40:55], v[200:203], v[64:67], v[40:55]
    v_mfma_f32_32x32x16_bf16 v[24:39], v[136:139], v[64:67], v[24:39]
    s_waitcnt vmcnt(12)
    v_mfma_f32_32x32x16_bf16 v[40:55], v[204:207], v[68:71], v[40:55]
    v_mfma_f32_32x32x16_bf16 v[24:39], v[140:143], v[68:71], v[24:39]
    v_or3_b32 v2, v64, v68, v2
    s_waitcnt vmcnt(11)
    v_mfma_f32_32x32x16_bf16 v[40:55], v[208:211], v[72:75], v[40:55]
    v_mfma_f32_32x32x16_bf16 v[24:39], v[144:147], v[72:75], v[24:39]
    s_waitcnt vmcnt(10)
    v_mfma_f32_32x32x16_bf16 v[40:55], v[212:215], v[76:79], v[40:55]
    v_mfma_f32_32x32x16_bf16 v[24:39], v[148:151], v[76:79], v[24:39]
    v_or3_b32 v2, v72, v76, v2
    s_waitcnt vmcnt(9)
    v_mfma_f32_32x32x16_bf16 v[40:55], v[216:219], v[80:83], v[40:55]
    v_mfma_f32_32x32x16_bf16 v[24:39], v[152:155], v[80:83], v[24:39]
    s_waitcnt vmcnt(8)
    v_mfma_f32_32x32x16_bf16 v[40:55], v[220:223], v[84:87], v[40:55]
    v_mfma_f32_32x32x16_bf16 v[24:39], v[156:159], v[84:87], v[24:39]
    v_or3_b32 v2, v80, v84, v2
    s_waitcnt vmcnt(7)
    v_mfma_f32_32x32x16_bf16 v[40:55], v[224:227], v[88:91], v[40:55]
    v_mfma_f32_32x32x16_bf16 v[24:39], v[160:163], v[88:91], v[24:39]
    s_waitcnt vmcnt(6)
    v_mfma_f32_32x32x16_bf16 v[40:55], v[228:231], v[92:95], v[40:55]
    v_mfma_f32_32x32x16_bf16 v[24:39], v[164:167], v[92:95], v[24:39]
    v_or3_b32 v2, v88, v92, v2
    s_waitcnt vmcnt(5)
    v_mfma_f32_32x32x16_bf16 v[40:55], v[232:235], v[96:99], v[40:55]
    v_mfma_f32_32x32x16_bf16 v[24:39], v[168:171], v[96:99], v[24:39]
    s_waitcnt vmcnt(4)
    v_mfma_f32_32x32x16_bf16 v[40:55], v[236:239], v[100:103], v[40:55]
    v_mfma_f32_32x32x16_bf16 v[24:39], v[172:175], v[100:103], v[24:39]
    v_or3_b32 v2, v96, v100, v2
    s_waitcnt vmcnt(3)
    v_mfma_f32_32x32x16_bf16 v[40:55], v[240:243], v[104:107], v[40:55]
    v_mfma_f32_32x32x16_bf16 v[24:39], v[176:179], v[104:107], v[24:39]
    s_waitcnt vmcnt(2)
    v_mfma_f32_32x32x16_bf16 v[40:55], v[244:247], v[108:111], v[40:55]
    v_mfma_f32_32x32x16_bf16 v[24:39], v[180:183], v[108:111], v[24:39]
    v_or3_b32 v2, v104, v108, v2
    s_waitcnt vmcnt(1)
    v_mfma_f32_32x32x16_bf16 v[40:55], v[248:251], v[112:115], v[40:55]
    v_mfma_f32_32x32x16_bf16 v[24:39], v[184:187], v[112:115], v[24:39]
    s_waitcnt vmcnt(0)
    v_mfma_f32_32x32x16_bf16 v[40:55], v[252:255], v[116:119], v[40:55]
    v_mfma_f32_32x32x16_bf16 v[24:39], v[188:191], v[116:119], v[24:39]
    v_or3_b32 v2, v112, v116, v2
    v_and_b32 v2, 1, v2
    v_cmp_ne_u32 vcc, 0, v2
    s_cbranch_vccz A3_ok
    s_cmp_eq_u32 s34, 0
    s_cbranch_scc1 A3_ok
    s_sub_u32 s34, s34, 1
    s_mov_b32 s47, 1
    s_sleep 2
    s_and_b32 s98, s34, 63
    s_cbranch_scc1 A3_again
    v_mov_b32 v2, s34
    buffer_store_dword v2, off, s[8:11], s96 sc1
    s_branch A3_again
A3_ok:
    s_nop 6
    ds_write_b128 v7, v[40:43] offset:0
    ds_write_b128 v7, v[44:47] offset:1024
    ds_write_b128 v7, v[48:51] offset:2048
    ds_write_b128 v7, v[52:55] offset:3072
    s_waitcnt lgkmcnt(0)
    s_barrier
    v_add_u32 v2, s48, v7
    ds_read_b128 v[40:43], v2 offset:0
    ds_read_b128 v[44:47], v2 offset:1024
    ds_read_b128 v[48:51], v2 offset:2048
    ds_read_b128 v[52:55], v2 offset:3072
    s_add_u32 s56, s55, 0x32000
    s_add_u32 s54, s54, 0x34000
    s_waitcnt lgkmcnt(0)
    v_pk_add_f32 v[24:25], v[24:25], v[40:41]
    v_pk_add_f32 v[26:27], v[26:27], v[42:43]
    v_pk_add_f32 v[28:29], v[28:29], v[44:45]
    v_pk_add_f32 v[30:31], v[30:31], v[46:47]
    v_pk_add_f32 v[32:33], v[32:33], v[48:49]
    v_pk_add_f32 v[34:35], v[34:35], v[50:51]
    v_pk_add_f32 v[36:37], v[36:37], v[52:53]
    v_pk_add_f32 v[38:39], v[38:39], v[54:55]
    v_cvt_pk_bf16_f32 v40, v24, v25
    v_cvt_pk_bf16_f32 v44, v32, v33
    v_add_u32_sdwa v40, v24, 1 dst_sel:WORD_0 dst_unused:UNUSED_PRESERVE src0_sel:WORD_1 src1_sel:DWORD
    v_add_u32_sdwa v44, v32, 1 dst_sel:WORD_0 dst_unused:UNUSED_PRESERVE src0_sel:WORD_1 src1_sel:DWORD
    v_cvt_pk_bf16_f32 v41, v26, v27
    v_cvt_pk_bf16_f32 v42, v28, v29
    v_cvt_pk_bf16_f32 v43, v30, v31
    v_cvt_pk_bf16_f32 v45, v34, v35
    v_cvt_pk_bf16_f32 v46, v36, v37
    v_cvt_pk_bf16_f32 v47, v38, v39
    v_and_b32 v40, -2, v40
    v_and_b32 v44, -2, v44
    buffer_store_dwordx4 v[40:43], v1, s[8:11], s54 offen sc1
    buffer_store_dwordx4 v[44:47], v1, s[8:11], s54 offen offset:1024 sc1
    v_pk_add_f32 v[60:61], v[24:25], v[26:27]
    v_pk_mul_f32 v[62:63], v[24:25], v[24:25]
    v_pk_fma_f32 v[62:63], v[26:27], v[26:27], v[62:63]
    v_pk_add_f32 v[60:61], v[60:61], v[28:29]
    v_pk_fma_f32 v[62:63], v[28:29], v[28:29], v[62:63]
    v_pk_add_f32 v[60:61], v[60:61], v[30:31]
    v_pk_fma_f32 v[62:63], v[30:31], v[30:31], v[62:63]
    v_pk_add_f32 v[60:61], v[60:61], v[32:33]
    v_pk_fma_f32 v[62:63], v[32:33], v[32:33], v[62:63]
    v_pk_add_f32 v[60:61], v[60:61], v[34:35]
    v_pk_fma_f32 v[62:63], v[34:35], v[34:35], v[62:63]
    v_pk_add_f32 v[60:61], v[60:61], v[36:37]
    v_pk_fma_f32 v[62:63], v[36:37], v[36:37], v[62:63]
    v_pk_add_f32 v[60:61], v[60:61], v[38:39]
    v_pk_fma_f32 v[62:63], v[38:39], v[38:39], v[62:63]
    v_add_f32 v60, v60, v61
    v_add_f32 v62, v62, v63
    v_lshlrev_b32 v61, 3, v3
    v_lshl_add_u32 v61, v4, 2, v61
    v_permlane32_swap_b32 v60, v62
    v_add_f32 v60, v60, v62
    v_and_b32 v60, -2, v60
    buffer_store_dword v60, v61, s[8:11], s56 offen sc1
    v_add_u32 v7, 98304, v6
    v_bfe_u32 v2, v1, 4, 4
    v_bfe_u32 v116, v1, 8, 1
    v_cmp_eq_u32 vcc, v2, v116
    v_mov_b32 v116, 0x3f803f80
    s_nop 0
    v_cndmask_b32 v112, 0, v116, vcc
    v_mov_b32 v113, v112
    v_mov_b32 v114, v112
    v_mov_b32 v115, v112
    s_cmp_lt_u32 s30, 3
    s_cselect_b32 s46, 0, s31
    s_barrier
    s_cmp_lg_u32 s46, 0
    s_cbranch_scc1 A4_nt
    ds_read_b64_tr_b16 v[128:129], v7 offset:0
    ds_read_b64_tr_b16 v[130:131], v7 offset:1024
    ds_read_b64_tr_b16 v[132:133], v7 offset:2048
    ds_read_b64_tr_b16 v[134:135], v7 offset:3072
    ds_read_b64_tr_b16 v[136:137], v7 offset:4096
    ds_read_b64_tr_b16 v[138:139], v7 offset:5120
    ds_read_b64_tr_b16 v[140:141], v7 offset:6144
    ds_read_b64_tr_b16 v[142:143], v7 offset:7168
    ds_read_b64_tr_b16 v[144:145], v7 offset:8192
    ds_read_b64_tr_b16 v[146:147], v7 offset:9216
    ds_read_b64_tr_b16 v[148:149], v7 offset:10240
    ds_read_b64_tr_b16 v[150:151], v7 offset:11264
    ds_read_b64_tr_b16 v[152:153], v7 offset:12288
    ds_read_b64_tr_b16 v[154:155], v7 offset:13312
    s_waitcnt lgkmcnt(12)
    v_mfma_f32_16x16x32_bf16 v[116:119], v[112:115], v[128:131], 0
    ds_read_b64_tr_b16 v[156:157], v7 offset:14336
    ds_read_b64_tr_b16 v[158:159], v7 offset:15360
    s_waitcnt lgkmcnt(12)
    v_mfma_f32_16x16x32_bf16 v[116:119], v[112:115], v[132:135], v[116:119]
    ds_read_b64_tr_b16 v[160:161], v7 offset:16384
    ds_read_b64_tr_b16 v[162:163], v7 offset:17408
    s_waitcnt lgkmcnt(12)
    v_mfma_f32_16x16x32_bf16 v[116:119], v[112:115], v[136:139], v[116:119]
    ds_read_b64_tr_b16 v[164:165], v7 offset:18432
    ds_read_b64_tr_b16 v[166:167], v7 offset:19456
    s_waitcnt lgkmcnt(12)
    v_mfma_f32_16x16x32_bf16 v[116:119], v[112:115], v[140:143], v[116:119]
    ds_read_b64_tr_b16 v[168:169], v7 offset:20480
    ds_read_b64_tr_b16 v[170:171], v7 offset:21504
    s_waitcnt lgkmcnt(12)
    v_mfma_f32_16x16x32_bf16 v[116:119], v[112:115], v[144:147], v[116:119]
    ds_read_b64_tr_b16 v[172:173], v7 offset:22528
    ds_read_b64_tr_b16 v[174:175], v7 offset:23552
    s_waitcnt lgkmcnt(12)
    v_mfma_f32_16x16x32_bf16 v[116:119], v[112:115], v[148:151], v[116:119]
    ds_read_b64_tr_b16 v[176:177], v7 offset:24576
    ds_read_b64_tr_b16 v[178:179], v7 offset:25600
    s_waitcnt lgkmcnt(12)
    v_mfma_f32_16x16x32_bf16 v[116:119], v[112:115], v[152:155], v[116:119]
    ds_read_b64_tr_b16 v[180:181], v7 offset:26624
    ds_read_b64_tr_b16 v[182:183], v7 offset:27648
    s_waitcnt lgkmcnt(12)
    v_mfma_f32_16x16x32_bf16 v[116:119], v[112:115], v[156:159], v[116:119]
    ds_read_b64_tr_b16 v[184:185], v7 offset:28672
    ds_read_b64_tr_b16 v[186:187], v7 offset:29696
    s_waitcnt lgkmcnt(12)
    v_mfma_f32_16x16x32_bf16 v[116:119], v[112:115], v[160:163], v[116:119]
    ds_read_b64_tr_b16 v[188:189], v7 offset:30720
    ds_read_b64_tr_b16 v[190:191], v7 offset:31744
    s_waitcnt lgkmcnt(12)
    v_mfma_f32_16x16x32_bf16 v[116:119], v[112:115], v[164:167], v[116:119]
    ds_read_b64_tr_b16 v[192:193], v7 offset:32768
    ds_read_b64_tr_b16 v[194:195], v7 offset:33792
    s_waitcnt lgkmcnt(12)
    v_mfma_f32_16x16x32_bf16 v[116:119], v[112:115], v[168:171], v[116:119]
    ds_read_b64_tr_b16 v[196:197], v7 offset:34816
    ds_read_b64_tr_b16 v[198:199], v7 offset:35840
    s_waitcnt lgkmcnt(12)
    v_mfma_f32_16x16x32_bf16 v[116:119], v[112:115], v[172:175], v[116:119]
    ds_read_b64_tr_b16 v[200:201], v7 offset:36864
    ds_read_b64_tr_b16 v[202:203], v7 offset:37888
    s_waitcnt lgkmcnt(12)
    v_mfma_f32_16x16x32_bf16 v[116:119], v[112:115], v[176:179], v[116:119]
    ds_read_b64_tr_b16 v[204:205], v7 offset:38912
    ds_read_b64_tr_b16 v[206:207], v7 offset:39936
    s_waitcnt lgkmcnt(12)
    v_mfma_f32_16x16x32_bf16 v[116:119], v[112:115], v[180:183], v[116:119]
    ds_read_b64_tr_b16 v[208:209], v7 offset:40960
    ds_read_b64_tr_b16 v[210:211], v7 offset:41984
    s_waitcnt lgkmcnt(12)
    v_mfma_f32_16x16x32_bf16 v[116:119], v[112:115], v[184:187], v[116:119]
    ds_read_b64_tr_b16 v[212:213], v7 offset:43008
    ds_read_b64_tr_b16 v[214:215], v7 offset:44032
    s_waitcnt lgkmcnt(12)
    v_mfma_f32_16x16x32_bf16 v[116:119], v[112:115], v[188:191], v[116:119]
    ds_read_b64_tr_b16 v[216:217], v7 offset:45056
    ds_read_b64_tr_b16 v[218:219], v7 offset:46080
    s_waitcnt lgkmcnt(12)
    v_mfma_f32_16x16x32_bf16 v[116:119], v[112:115], v[192:195], v[116:119]
    ds_read_b64_tr_b16 v[220:221], v7 offset:47104
    ds_read_b64_tr_b16 v[222:223], v7 offset:48128
    s_waitcnt lgkmcnt(12)
    v_mfma_f32_16x16x32_bf16 v[116:119], v[112:115], v[196:199], v[116:119]
    ds_read_b64_tr_b16 v[224:225], v7 offset:49152
    ds_read_b64_tr_b16 v[226:227], v7 offset:50176
    s_waitcnt lgkmcnt(12)
    v_mfma_f32_16x16x32_bf16 v[116:119], v[112:115], v[200:203], v[116:119]
    ds_read_b64_tr_b16 v[228:229], v7 offset:51200
    ds_read_b64_tr_b16 v[230:231], v7 offset:52224
    s_waitcnt lgkmcnt(12)
    v_mfma_f32_16x16x32_bf16 v[116:119], v[112:115], v[204:207], v[116:119]
    ds_read_b64_tr_b16 v[232:233], v7 offset:53248
    ds_read_b64_tr_b16 v[234:235], v7 offset:54272
    s_waitcnt lgkmcnt(12)
    v_mfma_f32_16x16x32_bf16 v[116:119], v[112:115], v[208:211], v[116:119]
    ds_read_b64_tr_b16 v[236:237], v7 offset:55296
    ds_read_b64_tr_b16 v[238:239], v7 offset:56320
    s_waitcnt lgkmcnt(12)
    v_mfma_f32_16x16x32_bf16 v[116:119], v[112:115], v[212:215], v[116:119]
    ds_read_b64_tr_b16 v[240:241], v7 offset:57344
    ds_read_b64_tr_b16 v[242:243], v7 offset:58368
    s_waitcnt lgkmcnt(12)
    v_mfma_f32_16x16x32_bf16 v[116:119], v[112:115], v[216:219], v[116:119]
    ds_read_b64_tr_b16 v[244:245], v7 offset:59392
    ds_read_b64_tr_b16 v[246:247], v7 offset:60416
    s_waitcnt lgkmcnt(12)
    v_mfma_f32_16x16x32_bf16 v[116:119], v[112:115], v[220:223], v[116:119]
    ds_read_b64_tr_b16 v[248:249], v7 offset:61440
    ds_read_b64_tr_b16 v[250:251], v7 offset:62464
    s_waitcnt lgkmcnt(12)
    v_mfma_f32_16x16x32_bf16 v[116:119], v[112:115], v[224:227], v[116:119]
    ds_read_b64_tr_b16 v[252:253], v7 offset:63488
    ds_read_b64_tr_b16 v[254:255], v7 offset:64512
    s_waitcnt lgkmcnt(12)
    v_mfma_f32_16x16x32_bf16 v[116:119], v[112:115], v[228:231], v[116:119]
    s_waitcnt lgkmcnt(10)
    v_mfma_f32_16x16x32_bf16 v[116:119], v[112:115], v[232:235], v[116:119]
    s_waitcnt lgkmcnt(8)
    v_mfma_f32_16x16x32_bf16 v[116:119], v[112:115], v[236:239], v[116:119]
    s_waitcnt lgkmcnt(6)
    v_mfma_f32_16x16x32_bf16 v[116:119], v[112:115], v[240:243], v[116:119]
    s_waitcnt lgkmcnt(4)
    v_mfma_f32_16x16x32_bf16 v[116:119], v[112:115], v[244:247], v[116:119]
    s_waitcnt lgkmcnt(2)
    v_mfma_f32_16x16x32_bf16 v[116:119], v[112:115], v[248:251], v[116:119]
    s_waitcnt lgkmcnt(0)
    v_mfma_f32_16x16x32_bf16 v[116:119], v[112:115], v[252:255], v[116:119]
A4_nt:
    s_xor_b32 s58, s3, 4
    s_lshl_b32 s58, s58, 13
    s_add_u32 s57, s58, 98304
    v_add_u32 v48, s57, v1
    s_add_u32 s58, s58, s36
    s_add_u32 s58, s58, 0x34000
    s_add_u32 s61, s58, 4096
    s_waitcnt vmcnt(0)
    s_barrier
    v_and_b32 v60, 0x380, v1
    v_add_u32 v60, v60, v1
    s_lshl_b32 s43, s35, 12
    s_lshl_b32 s42, s31, 7
    s_add_u32 s43, s43, s42
    s_add_u32 s43, s43, s36
    s_add_u32 s43, s43, 0x32000
    buffer_load_dwordx4 v[52:55], v60, s[8:11], s43 offen offset:0 sc1
    buffer_load_dwordx4 v[56:59], v60, s[8:11], s43 offen offset:2048 sc1
    v_lshlrev_b32 v8, 16, v120
    v_and_b32 v9, 0xffff0000, v120
    v_lshlrev_b32 v10, 16, v121
    v_and_b32 v11, 0xffff0000, v121
    v_lshlrev_b32 v12, 16, v122
    v_and_b32 v13, 0xffff0000, v122
    v_lshlrev_b32 v14, 16, v123
    v_and_b32 v15, 0xffff0000, v123
    v_lshlrev_b32 v16, 16, v124
    v_and_b32 v17, 0xffff0000, v124
    v_lshlrev_b32 v18, 16, v125
    v_and_b32 v19, 0xffff0000, v125
    v_lshlrev_b32 v20, 16, v126
    v_and_b32 v21, 0xffff0000, v126
    v_lshlrev_b32 v22, 16, v127
    v_and_b32 v23, 0xffff0000, v127
    v_pk_add_f32 v[8:9], v[8:9], v[24:25]
    v_pk_add_f32 v[10:11], v[10:11], v[26:27]
    v_pk_add_f32 v[12:13], v[12:13], v[28:29]
    v_pk_add_f32 v[14:15], v[14:15], v[30:31]
    v_pk_add_f32 v[16:17], v[16:17], v[32:33]
    v_pk_add_f32 v[18:19], v[18:19], v[34:35]
    v_pk_add_f32 v[20:21], v[20:21], v[36:37]
    v_pk_add_f32 v[22:23], v[22:23], v[38:39]
    s_lshl_b32 s62, s3, 2
    s_cmp_eq_u32 s3, 3
    s_subb_u32 s62, s62, s35
    s_lshl_b32 s59, s3, 14
    s_lshl_b32 s60, s62, 11
    s_sub_u32 s60, s60, s59
    s_add_u32 s60, s60, 65536
    s_lshl_b32 s62, s62, 10
    s_add_u32 s62, s62, s36
    s_add_u32 s62, s62, 32768
    s_lshl_b32 s50, s3, 13
    s_add_u32 s50, s50, s36
    s_add_u32 s42, s31, 4
    s_lshl_b32 s49, s42, 7
    s_add_u32 s49, s49, 94464
    s_add_u32 s42, s42, s37
    s_lshl_b32 s42, s42, 11
    s_mul_i32 s56, s35, 88064
    s_add_u32 s42, s42, s56
    s_add_u32 s56, s42, s36
    s_mov_b32 s51, s35
    s_mov_b32 s52, s35
    v_lshrrev_b32 v2, 2, v1
    v_add_u32 v2, s49, v2
    s_mov_b64 exec, 0xffff
    ds_write_b32 v2, v116
    ds_write_b32 v2, v117 offset:64
    s_mov_b64 exec, -1
    v_lshl_add_u32 v5, v4, 4, s49
    s_lshl_b32 s42, s35, 9
    s_add_u32 s42, s42, 96256
    v_lshl_add_u32 v7, v3, 4, s42
    v_add_u32 v6, s59, v6
    v_xor_b32 v0, 64, v6
    ds_read_b64_tr_b16 v[64:65], v6 offset:0
    ds_read_b64_tr_b16 v[66:67], v6 offset:1024
    ds_read_b64_tr_b16 v[68:69], v0 offset:0
    ds_read_b64_tr_b16 v[70:71], v0 offset:1024
    ds_read_b64_tr_b16 v[72:73], v6 offset:2048
    ds_read_b64_tr_b16 v[74:75], v6 offset:3072
    ds_read_b64_tr_b16 v[76:77], v0 offset:2048
    ds_read_b64_tr_b16 v[78:79], v0 offset:3072
    ds_read_b64_tr_b16 v[80:81], v6 offset:4096
    ds_read_b64_tr_b16 v[82:83], v6 offset:5120
    ds_read_b64_tr_b16 v[84:85], v0 offset:4096
    ds_read_b64_tr_b16 v[86:87], v0 offset:5120
    ds_read_b64_tr_b16 v[88:89], v6 offset:6144
    ds_read_b64_tr_b16 v[90:91], v6 offset:7168
    ds_read_b64_tr_b16 v[92:93], v0 offset:6144
    ds_read_b64_tr_b16 v[94:95], v0 offset:7168
    ds_read_b64_tr_b16 v[96:97], v6 offset:8192
    ds_read_b64_tr_b16 v[98:99], v6 offset:9216
    ds_read_b64_tr_b16 v[100:101], v0 offset:8192
    ds_read_b64_tr_b16 v[102:103], v0 offset:9216
    ds_read_b64_tr_b16 v[104:105], v6 offset:10240
    ds_read_b64_tr_b16 v[106:107], v6 offset:11264
    ds_read_b64_tr_b16 v[108:109], v0 offset:10240
    ds_read_b64_tr_b16 v[110:111], v0 offset:11264
    ds_read_b64_tr_b16 v[112:113], v6 offset:12288
    ds_read_b64_tr_b16 v[114:115], v6 offset:13312
    ds_read_b64_tr_b16 v[116:117], v0 offset:12288
    ds_read_b64_tr_b16 v[118:119], v0 offset:13312
    ds_read_b64_tr_b16 v[120:121], v6 offset:14336
    ds_read_b64_tr_b16 v[122:123], v6 offset:15360
    ds_read_b64_tr_b16 v[124:125], v0 offset:14336
    ds_read_b64_tr_b16 v[126:127], v0 offset:15360
    s_mov_b32 m0, s57
    s_nop 0
    buffer_load_dwordx4 v1, s[8:11], s58 offen offset:0 sc1 lds
    buffer_load_dwordx4 v1, s[8:11], s58 offen offset:1024 sc1 lds
    buffer_load_dwordx4 v1, s[8:11], s58 offen offset:2048 sc1 lds
    buffer_load_dwordx4 v1, s[8:11], s58 offen offset:3072 sc1 lds
    s_add_u32 m0, s57, 4096
    s_nop 0
    buffer_load_dwordx4 v1, s[8:11], s61 offen offset:0 sc1 lds
    buffer_load_dwordx4 v1, s[8:11], s61 offen offset:1024 sc1 lds
    buffer_load_dwordx4 v1, s[8:11], s61 offen offset:2048 sc1 lds
    buffer_load_dwordx4 v1, s[8:11], s61 offen offset:3072 sc1 lds
    s_barrier
A4_body:
    s_waitcnt vmcnt(8)
    v_or3_b32 v2, v52, v53, 0
    v_or3_b32 v2, v54, v55, v2
    v_or3_b32 v2, v56, v57, v2
    v_or3_b32 v2, v58, v59, v2
    v_add_f32 v52, v52, v56
    v_add_f32 v53, v53, v57
    v_add_f32 v54, v54, v58
    v_add_f32 v55, v55, v59
    s_and_b32 s42, s3, 3
    s_lshl_b32 s42, s42, 8
    s_add_u32 s42, s42, 96256
    v_and_b32 v60, 0x70, v1
    v_permlane32_swap_b32 v52, v54
    v_permlane32_swap_b32 v53, v55
    v_add_f32 v52, v52, v54
    v_add_f32 v53, v53, v55
    v_lshl_add_u32 v60, v4, 3, v60
    v_lshlrev_b32 v60, 1, v60
    v_permlane16_swap_b32 v52, v53
    v_add_f32 v52, v52, v53
    v_add_u32 v60, s42, v60
    s_nop 0
    v_add_f32_dpp v52, v52, v52 row_ror:8 row_mask:0xf bank_mask:0xf
    v_mul_f32 v52, 0x3b000000, v52
    v_mov_b32 v53, v52
    s_nop 1
    v_permlane16_swap_b32 v52, v53
    v_fma_f32 v53, -v52, v52, v53
    v_max_f32 v53, 0, v53
    v_add_f32 v55, 0x3727c5ac, v53
    v_rsq_f32 v54, v55
    v_sub_f32 v52, 0, v52
    v_mul_f32 v55, v55, v54
    v_mul_f32 v56, v54, v54
    v_mul_f32 v53, 0xc0135761, v54
    v_mul_f32 v54, s44, v54
    v_mul_f32 v54, v54, v56
    ds_write_b128 v60, v[52:55]
    s_waitcnt vmcnt(4)
    ds_read_b32 v40, v48 offset:0
    ds_read_b32 v41, v48 offset:1024
    ds_read_b32 v42, v48 offset:2048
    ds_read_b32 v43, v48 offset:3072
    s_waitcnt vmcnt(2)
    ds_read_b32 v44, v48 offset:4096
    ds_read_b32 v45, v48 offset:5120
    s_waitcnt vmcnt(0)
    ds_read_b32 v46, v48 offset:6144
    ds_read_b32 v47, v48 offset:7168
    s_waitcnt lgkmcnt(2)
    v_or3_b32 v2, v40, v41, v2
    v_or3_b32 v2, v42, v43, v2
    v_or3_b32 v2, v44, v45, v2
    s_waitcnt lgkmcnt(0)
    v_or3_b32 v2, v46, v47, v2
    v_and_b32 v2, 1, v2
    v_cmp_ne_u32 vcc, 0, v2
    s_cbranch_vccz A4_ok
    s_cmp_eq_u32 s34, 0
    s_cbranch_scc1 A4_ok
    s_sub_u32 s34, s34, 1
    s_mov_b32 s47, 1
    s_sleep 2
    s_and_b32 s98, s34, 63
    s_cbranch_scc1 A4_again
    v_mov_b32 v2, s34
    buffer_store_dword v2, off, s[8:11], s96 sc1
    s_branch A4_again
A4_ok:
    s_lshl_b32 s42, s35, 15
    s_add_u32 s42, s42, 98304
    v_add_u32 v2, s42, v1
    v_add_u32 v6, s60, v6
    v_add_u32 v0, s60, v0
    s_setprio 2
    s_barrier
    s_cmp_lg_u32 s46, 0
    s_cbranch_scc1 A5_idle
    ds_read_b128 v[40:43], v2 offset:0
    ds_read_b128 v[44:47], v2 offset:1024
    ds_read_b128 v[48:51], v2 offset:2048
    ds_read_b128 v[52:55], v2 offset:3072
    ds_read_b128 v[56:59], v2 offset:4096
    ds_read_b128 v[60:63], v2 offset:5120
    s_waitcnt lgkmcnt(5)
    v_mfma_f32_32x32x16_bf16 v[24:39], v[128:131], v[40:43], 0
    ds_read_b128 v[40:43], v2 offset:6144
    s_waitcnt lgkmcnt(5)
    v_mfma_f32_32x32x16_bf16 v[24:39], v[132:135], v[44:47], v[24:39]
    ds_read_b128 v[44:47], v2 offset:7168
    s_waitcnt lgkmcnt(5)
    v_mfma_f32_32x32x16_bf16 v[24:39], v[136:139], v[48:51], v[24:39]
    ds_read_b128 v[48:51], v2 offset:8192
    s_waitcnt lgkmcnt(5)
    v_mfma_f32_32x32x16_bf16 v[24:39], v[140:143], v[52:55], v[24:39]
    ds_read_b128 v[52:55], v2 offset:9216
    s_waitcnt lgkmcnt(5)
    v_mfma_f32_32x32x16_bf16 v[24:39], v[144:147], v[56:59], v[24:39]
    ds_read_b128 v[56:59], v2 offset:10240
    s_waitcnt lgkmcnt(5)
    v_mfma_f32_32x32x16_bf16 v[24:39], v[148:151], v[60:63], v[24:39]
    ds_read_b128 v[60:63], v2 offset:11264
    s_waitcnt lgkmcnt(5)
    v_mfma_f32_32x32x16_bf16 v[24:39], v[152:155], v[40:43], v[24:39]
    ds_read_b128 v[40:43], v2 offset:12288
    s_waitcnt lgkmcnt(5)
    v_mfma_f32_32x32x16_bf16 v[24:39], v[156:159], v[44:47], v[24:39]
    ds_read_b128 v[44:47], v2 offset:13312
    s_waitcnt lgkmcnt(5)
    v_mfma_f32_32x32x16_bf16 v[24:39], v[160:163], v[48:51], v[24:39]
    ds_read_b128 v[48:51], v2 offset:14336
    s_waitcnt lgkmcnt(5)
    v_mfma_f32_32x32x16_bf16 v[24:39], v[164:167], v[52:55], v[24:39]
    ds_read_b128 v[52:55], v2 offset:15360
    s_waitcnt lgkmcnt(5)
    v_mfma_f32_32x32x16_bf16 v[24:39], v[168:171], v[56:59], v[24:39]
    ds_read_b128 v[56:59], v2 offset:16384
    s_waitcnt lgkmcnt(5)
    v_mfma_f32_32x32x16_bf16 v[24:39], v[172:175], v[60:63], v[24:39]
    ds_read_b128 v[60:63], v2 offset:17408
    s_waitcnt lgkmcnt(5)
    v_mfma_f32_32x32x16_bf16 v[24:39], v[176:179], v[40:43], v[24:39]
    ds_read_b128 v[40:43], v2 offset:18432
    s_waitcnt lgkmcnt(5)
    v_mfma_f32_32x32x16_bf16 v[24:39], v[180:183], v[44:47], v[24:39]
    ds_read_b128 v[44:47], v2 offset:19456
    s_waitcnt lgkmcnt(5)
    v_mfma_f32_32x32x16_bf16 v[24:39], v[184:187], v[48:51], v[24:39]
    ds_read_b128 v[48:51], v2 offset:20480
    s_waitcnt lgkmcnt(5)
    v_mfma_f32_32x32x16_bf16 v[24:39], v[188:191], v[52:55], v[24:39]
    ds_read_b128 v[52:55], v2 offset:21504
    s_waitcnt lgkmcnt(5)
    v_mfma_f32_32x32x16_bf16 v[24:39], v[192:195], v[56:59], v[24:39]
    ds_read_b128 v[56:59], v2 offset:22528
    s_waitcnt lgkmcnt(5)
    v_mfma_f32_32x32x16_bf16 v[24:39], v[196:199], v[60:63], v[24:39]
    ds_read_b128 v[60:63], v2 offset:23552
    s_waitcnt lgkmcnt(5)
    v_mfma_f32_32x32x16_bf16 v[24:39], v[200:203], v[40:43], v[24:39]
    ds_read_b128 v[40:43], v2 offset:24576
    s_waitcnt lgkmcnt(5)
    v_mfma_f32_32x32x16_bf16 v[24:39], v[204:207], v[44:47], v[24:39]
    ds_read_b128 v[44:47], v2 offset:25600
    s_waitcnt lgkmcnt(5)
    v_mfma_f32_32x32x16_bf16 v[24:39], v[208:211], v[48:51], v[24:39]
    ds_read_b128 v[48:51], v2 offset:26624
    s_waitcnt lgkmcnt(5)
    v_mfma_f32_32x32x16_bf16 v[24:39], v[212:215], v[52:55], v[24:39]
    ds_read_b128 v[52:55], v2 offset:27648
    s_waitcnt lgkmcnt(5)
    v_mfma_f32_32x32x16_bf16 v[24:39], v[216:219], v[56:59], v[24:39]
    ds_read_b128 v[56:59], v2 offset:28672
    s_waitcnt lgkmcnt(5)
    v_mfma_f32_32x32x16_bf16 v[24:39], v[220:223], v[60:63], v[24:39]
    ds_read_b128 v[60:63], v2 offset:29696
    s_waitcnt lgkmcnt(5)
    v_mfma_f32_32x32x16_bf16 v[24:39], v[224:227], v[40:43], v[24:39]
    ds_read_b128 v[40:43], v2 offset:30720
    s_waitcnt lgkmcnt(5)
    v_mfma_f32_32x32x16_bf16 v[24:39], v[228:231], v[44:47], v[24:39]
    ds_read_b128 v[44:47], v2 offset:31744
    s_waitcnt lgkmcnt(5)
    v_mfma_f32_32x32x16_bf16 v[24:39], v[232:235], v[48:51], v[24:39]
    ds_read_b128 v[48:51], v5 offset:0
    s_waitcnt lgkmcnt(5)
    v_mfma_f32_32x32x16_bf16 v[24:39], v[236:239], v[52:55], v[24:39]
    ds_read_b128 v[52:55], v5 offset:32
    s_waitcnt lgkmcnt(5)
    v_mfma_f32_32x32x16_bf16 v[24:39], v[240:243], v[56:59], v[24:39]
    ds_read_b128 v[56:59], v5 offset:64
    s_waitcnt lgkmcnt(5)
    v_mfma_f32_32x32x16_bf16 v[24:39], v[244:247], v[60:63], v[24:39]
    ds_read_b128 v[60:63], v5 offset:96
    s_waitcnt lgkmcnt(5)
    v_mfma_f32_32x32x16_bf16 v[24:39], v[248:251], v[40:43], v[24:39]
    ds_read_b128 v[40:43], v7 offset:0
    s_waitcnt lgkmcnt(5)
    v_mfma_f32_32x32x16_bf16 v[24:39], v[252:255], v[44:47], v[24:39]
    s_waitcnt lgkmcnt(0)
    s_nop 10
    v_fmac_f32 v24, v48, v40
    v_fmac_f32 v25, v49, v40
    v_fmac_f32 v26, v50, v40
    v_fmac_f32 v27, v51, v40
    v_fmac_f32 v28, v52, v40
    v_fmac_f32 v29, v53, v40
    v_fmac_f32 v30, v54, v40
    v_fmac_f32 v31, v55, v40
    v_fmac_f32 v32, v56, v40
    v_fmac_f32 v33, v57, v40
    v_fmac_f32 v34, v58, v40
    v_fmac_f32 v35, v59, v40
    v_fmac_f32 v36, v60, v40
    v_fmac_f32 v37, v61, v40
    v_fmac_f32 v38, v62, v40
    v_fmac_f32 v39, v63, v40
    v_mul_f32 v48, v24, v24
    v_mul_f32 v49, v25, v25
    v_mul_f32 v50, v26, v26
    v_mul_f32 v51, v27, v27
    v_mul_f32 v52, v28, v28
    v_mul_f32 v53, v29, v29
    v_mul_f32 v54, v30, v30
    v_mul_f32 v55, v31, v31
    v_mul_f32 v56, v32, v32
    v_mul_f32 v57, v33, v33
    v_mul_f32 v58, v34, v34
    v_mul_f32 v59, v35, v35
    v_mul_f32 v60, v36, v36
    v_mul_f32 v61, v37, v37
    v_mul_f32 v62, v38, v38
    v_mul_f32 v63, v39, v39
    v_fma_f32 v48, v48, v42, v41
    v_fma_f32 v49, v49, v42, v41
    v_fma_f32 v50, v50, v42, v41
    v_fma_f32 v51, v51, v42, v41
    v_fma_f32 v52, v52, v42, v41
    v_fma_f32 v53, v53, v42, v41
    v_fma_f32 v54, v54, v42, v41
    v_fma_f32 v55, v55, v42, v41
    v_fma_f32 v56, v56, v42, v41
    v_fma_f32 v57, v57, v42, v41
    v_fma_f32 v58, v58, v42, v41
    v_fma_f32 v59, v59, v42, v41
    v_fma_f32 v60, v60, v42, v41
    v_fma_f32 v61, v61, v42, v41
    v_fma_f32 v62, v62, v42, v41
    v_fma_f32 v63, v63, v42, v41
    v_mul_f32 v48, v48, v24
    v_mul_f32 v49, v49, v25
    v_mul_f32 v50, v50, v26
    v_mul_f32 v51, v51, v27
    v_mul_f32 v52, v52, v28
    v_mul_f32 v53, v53, v29
    v_mul_f32 v54, v54, v30
    v_mul_f32 v55, v55, v31
    v_mul_f32 v56, v56, v32
    v_mul_f32 v57, v57, v33
    v_mul_f32 v58, v58, v34
    v_mul_f32 v59, v59, v35
    v_mul_f32 v60, v60, v36
    v_mul_f32 v61, v61, v37
    v_mul_f32 v62, v62, v38
    v_mul_f32 v63, v63, v39
    v_exp_f32 v48, v48
    v_exp_f32 v49, v49
    v_exp_f32 v50, v50
    v_exp_f32 v51, v51
    v_exp_f32 v52, v52
    v_exp_f32 v53, v53
    v_exp_f32 v54, v54
    v_exp_f32 v55, v55
    v_exp_f32 v56, v56
    v_exp_f32 v57, v57
    v_exp_f32 v58, v58
    v_exp_f32 v59, v59
    v_exp_f32 v60, v60
    v_exp_f32 v61, v61
    v_exp_f32 v62, v62
    v_exp_f32 v63, v63
    v_fma_f32 v48, v48, v43, v43
    v_fma_f32 v49, v49, v43, v43
    v_fma_f32 v50, v50, v43, v43
    v_fma_f32 v51, v51, v43, v43
    v_fma_f32 v52, v52, v43, v43
    v_fma_f32 v53, v53, v43, v43
    v_fma_f32 v54, v54, v43, v43
    v_fma_f32 v55, v55, v43, v43
    v_fma_f32 v56, v56, v43, v43
    v_fma_f32 v57, v57, v43, v43
    v_fma_f32 v58, v58, v43, v43
    v_fma_f32 v59, v59, v43, v43
    v_fma_f32 v60, v60, v43, v43
    v_fma_f32 v61, v61, v43, v43
    v_fma_f32 v62, v62, v43, v43
    v_fma_f32 v63, v63, v43, v43
    v_rcp_f32 v48, v48
    v_rcp_f32 v49, v49
    v_rcp_f32 v50, v50
    v_rcp_f32 v51, v51
    v_rcp_f32 v52, v52
    v_rcp_f32 v53, v53
    v_rcp_f32 v54, v54
    v_rcp_f32 v55, v55
    v_rcp_f32 v56, v56
    v_rcp_f32 v57, v57
    v_rcp_f32 v58, v58
    v_rcp_f32 v59, v59
    v_rcp_f32 v60, v60
    v_rcp_f32 v61, v61
    v_rcp_f32 v62, v62
    v_rcp_f32 v63, v63
    v_mul_f32 v24, v24, v48
    v_mul_f32 v25, v25, v49
    v_mul_f32 v26, v26, v50
    v_mul_f32 v27, v27, v51
    v_mul_f32 v28, v28, v52
    v_mul_f32 v29, v29, v53
    v_mul_f32 v30, v30, v54
    v_mul_f32 v31, v31, v55
    v_mul_f32 v32, v32, v56
    v_mul_f32 v33, v33, v57
    v_mul_f32 v34, v34, v58
    v_mul_f32 v35, v35, v59
    v_mul_f32 v36, v36, v60
    v_mul_f32 v37, v37, v61
    v_mul_f32 v38, v38, v62
    v_mul_f32 v39, v39, v63
    v_cvt_pk_bf16_f32 v56, v24, v25
    v_cvt_pk_bf16_f32 v60, v32, v33
    v_or_b32_sdwa v56, v24, 1 dst_sel:WORD_0 dst_unused:UNUSED_PRESERVE src0_sel:WORD_1 src1_sel:DWORD
    v_or_b32_sdwa v60, v32, 1 dst_sel:WORD_0 dst_unused:UNUSED_PRESERVE src0_sel:WORD_1 src1_sel:DWORD
    v_cvt_pk_bf16_f32 v57, v26, v27
    v_cvt_pk_bf16_f32 v58, v28, v29
    v_cvt_pk_bf16_f32 v59, v30, v31
    v_cvt_pk_bf16_f32 v61, v34, v35
    v_cvt_pk_bf16_f32 v62, v36, v37
    v_cvt_pk_bf16_f32 v63, v38, v39
    buffer_store_dwordx4 v[56:59], v1, s[8:11], s56 offen sc1
    buffer_store_dwordx4 v[60:63], v1, s[8:11], s56 offen offset:1024 sc1
    s_cmp_lg_u32 s3, 0
    s_cbranch_scc1 A5_ld
    s_xor_b32 s97, s97, 2
    s_or_b32 s97, s97, 0x10000
    v_mov_b32 v2, s97
    buffer_store_dword v2, off, s[8:11], s96 sc1
A5_ld:
    s_add_u32 s42, s62, 0
    s_cmp_gt_u32 s51, 0
    s_cbranch_scc1 W5_i00
    buffer_load_dwordx4 v[128:131], v1, s[8:11], s42 offen offset:0 sc1
W5_i00:
    s_cmp_gt_u32 s51, 1
    s_cbranch_scc1 W5_i01
    buffer_load_dwordx4 v[132:135], v1, s[8:11], s42 offen offset:1024 sc1
W5_i01:
    buffer_load_dwordx4 v[136:139], v1, s[8:11], s42 offen offset:2048 sc1
    buffer_load_dwordx4 v[140:143], v1, s[8:11], s42 offen offset:3072 sc1
    s_add_u32 s42, s50, 0
    buffer_load_dwordx4 v[144:147], v1, s[8:11], s42 offen offset:0 sc1
    buffer_load_dwordx4 v[148:151], v1, s[8:11], s42 offen offset:1024 sc1
    buffer_load_dwordx4 v[152:155], v1, s[8:11], s42 offen offset:2048 sc1
    buffer_load_dwordx4 v[156:159], v1, s[8:11], s42 offen offset:3072 sc1
    s_add_u32 s42, s50, 4096
    buffer_load_dwordx4 v[160:163], v1, s[8:11], s42 offen offset:0 sc1
    buffer_load_dwordx4 v[164:167], v1, s[8:11], s42 offen offset:1024 sc1
    buffer_load_dwordx4 v[168:171], v1, s[8:11], s42 offen offset:2048 sc1
    buffer_load_dwordx4 v[172:175], v1, s[8:11], s42 offen offset:3072 sc1
    s_setprio 0
    ds_read_b64_tr_b16 v[32:33], v6 offset:0
    ds_read_b64_tr_b16 v[34:35], v6 offset:1024
    ds_read_b64_tr_b16 v[36:37], v0 offset:0
    ds_read_b64_tr_b16 v[38:39], v0 offset:1024
    ds_read_b64_tr_b16 v[40:41], v6 offset:2048
    ds_read_b64_tr_b16 v[42:43], v6 offset:3072
    ds_read_b64_tr_b16 v[44:45], v0 offset:2048
    ds_read_b64_tr_b16 v[46:47], v0 offset:3072
    ds_read_b64_tr_b16 v[48:49], v6 offset:4096
    ds_read_b64_tr_b16 v[50:51], v6 offset:5120
    ds_read_b64_tr_b16 v[52:53], v0 offset:4096
    ds_read_b64_tr_b16 v[54:55], v0 offset:5120
    ds_read_b64_tr_b16 v[56:57], v6 offset:6144
    ds_read_b64_tr_b16 v[58:59], v6 offset:7168
    ds_read_b64_tr_b16 v[60:61], v0 offset:6144
    ds_read_b64_tr_b16 v[62:63], v0 offset:7168
    s_waitcnt lgkmcnt(0)
    s_mul_i32 s42, s3, 8448
    s_add_u32 s42, s42, 0
    v_lshl_add_u32 v6, v4, 4, v1
    v_add_u32 v6, s42, v6
    s_mul_i32 s42, s31, 4224
    v_add_u32 v5, s42, v6
    s_sub_u32 s42, 4224, s42
    v_add_u32 v6, s42, v6
    v_bfe_u32 v0, v1, 8, 1
    v_lshl_add_u32 v0, v0, 4, v4
    s_lshl_b32 s42, s3, 1
    v_add_u32 v0, s42, v0
    v_and_b32 v2, 15, v3
    v_mul_u32_u24 v7, 528, v2
    v_lshl_add_u32 v7, v0, 4, v7
    v_add_u32 v7, 0, v7
    v_lshlrev_b32 v0, 10, v0
    v_lshl_add_u32 v0, v2, 3, v0
    s_lshl_b32 s53, s28, 16
    s_lshl_b32 s42, s30, 7
    s_add_u32 s53, s53, s42
    s_add_u32 s54, s53, 0x8000
    v_add_u32 v3, 94208, v6
    s_barrier
W5_body:
    s_waitcnt vmcnt(9)
    v_mfma_f32_32x32x16_bf16 v[240:255], v[52:55], v[136:139], 0
    s_cmp_lg_u32 s52, 0
    s_cbranch_scc1 W5_z
    v_mfma_f32_32x32x16_bf16 v[224:239], v[48:51], v[136:139], v[8:23]
    s_branch W5_y
W5_z:
    v_mfma_f32_32x32x16_bf16 v[224:239], v[48:51], v[136:139], 0
W5_y:
    v_mov_b32 v2, v136
    s_cmp_gt_u32 s51, 1
    s_cbranch_scc1 W5_m1
    v_mfma_f32_32x32x16_bf16 v[240:255], v[44:47], v[132:135], v[240:255]
    v_mfma_f32_32x32x16_bf16 v[224:239], v[40:43], v[132:135], v[224:239]
    v_and_b32 v2, v2, v132
W5_m1:
    s_cmp_gt_u32 s51, 0
    s_cbranch_scc1 W5_m0
    v_mfma_f32_32x32x16_bf16 v[240:255], v[36:39], v[128:131], v[240:255]
    v_mfma_f32_32x32x16_bf16 v[224:239], v[32:35], v[128:131], v[224:239]
    v_and_b32 v2, v2, v128
W5_m0:
    s_waitcnt vmcnt(8)
    v_mfma_f32_32x32x16_bf16 v[240:255], v[60:63], v[140:143], v[240:255]
    v_mfma_f32_32x32x16_bf16 v[224:239], v[56:59], v[140:143], v[224:239]
    v_and_b32 v2, v2, v140
    s_waitcnt vmcnt(7)
    v_mfma_f32_32x32x16_bf16 v[240:255], v[68:71], v[144:147], v[240:255]
    v_mfma_f32_32x32x16_bf16 v[224:239], v[64:67], v[144:147], v[224:239]
    v_and_b32 v2, v2, v144
    s_waitcnt vmcnt(6)
    v_mfma_f32_32x32x16_bf16 v[240:255], v[76:79], v[148:151], v[240:255]
    v_mfma_f32_32x32x16_bf16 v[224:239], v[72:75], v[148:151], v[224:239]
    v_and_b32 v2, v2, v148
    s_waitcnt vmcnt(5)
    v_mfma_f32_32x32x16_bf16 v[240:255], v[84:87], v[152:155], v[240:255]
    v_mfma_f32_32x32x16_bf16 v[224:239], v[80:83], v[152:155], v[224:239]
    v_and_b32 v2, v2, v152
    s_waitcnt vmcnt(4)
    v_mfma_f32_32x32x16_bf16 v[240:255], v[92:95], v[156:159], v[240:255]
    v_mfma_f32_32x32x16_bf16 v[224:239], v[88:91], v[156:159], v[224:239]
    v_and_b32 v2, v2, v156
    s_waitcnt vmcnt(3)
    v_mfma_f32_32x32x16_bf16 v[240:255], v[100:103], v[160:163], v[240:255]
    v_mfma_f32_32x32x16_bf16 v[224:239], v[96:99], v[160:163], v[224:239]
    v_and_b32 v2, v2, v160
    s_waitcnt vmcnt(2)
    v_mfma_f32_32x32x16_bf16 v[240:255], v[108:111], v[164:167], v[240:255]
    v_mfma_f32_32x32x16_bf16 v[224:239], v[104:107], v[164:167], v[224:239]
    v_and_b32 v2, v2, v164
    s_waitcnt vmcnt(1)
    v_mfma_f32_32x32x16_bf16 v[240:255], v[116:119], v[168:171], v[240:255]
    v_mfma_f32_32x32x16_bf16 v[224:239], v[112:115], v[168:171], v[224:239]
    v_and_b32 v2, v2, v168
    s_waitcnt vmcnt(0)
    v_mfma_f32_32x32x16_bf16 v[240:255], v[124:127], v[172:175], v[240:255]
    v_mfma_f32_32x32x16_bf16 v[224:239], v[120:123], v[172:175], v[224:239]
    v_and_b32 v2, v2, v172
    v_and_b32 v2, 1, v2
    v_cmp_ne_u32 vcc, 1, v2
    s_cbranch_vccz W5_ok
    s_cmp_eq_u32 s34, 0
    s_cbranch_scc1 W5_ok
    s_sub_u32 s34, s34, 1
    s_mov_b32 s47, 1
    s_sleep 2
    s_and_b32 s98, s34, 63
    s_cbranch_scc1 W5_again
    v_mov_b32 v2, s34
    buffer_store_dword v2, off, s[8:11], s96 sc1
    s_branch W5_again
W5_ok:
    s_add_u32 s42, s62, 88064
    s_cmp_gt_u32 s51, 0
    s_cbranch_scc1 W8_i10
    buffer_load_dwordx4 v[176:179], v1, s[8:11], s42 offen offset:0 sc1
W8_i10:
    s_add_u32 s42, s62, 88064
    s_cmp_gt_u32 s51, 1
    s_cbranch_scc1 W8_i11
    buffer_load_dwordx4 v[180:183], v1, s[8:11], s42 offen offset:1024 sc1
W8_i11:
    s_add_u32 s42, s62, 88064
    buffer_load_dwordx4 v[184:187], v1, s[8:11], s42 offen offset:2048 sc1
    ds_write_b128 v6, v[240:243] offset:0
    s_add_u32 s42, s62, 88064
    buffer_load_dwordx4 v[188:191], v1, s[8:11], s42 offen offset:3072 sc1
    ds_write_b128 v6, v[244:247] offset:1056
    s_add_u32 s42, s50, 88064
    buffer_load_dwordx4 v[192:195], v1, s[8:11], s42 offen offset:0 sc1
    ds_write_b128 v6, v[248:251] offset:2112
    s_add_u32 s42, s50, 88064
    buffer_load_dwordx4 v[196:199], v1, s[8:11], s42 offen offset:1024 sc1
    ds_write_b128 v6, v[252:255] offset:3168
    s_waitcnt vmcnt(3)
    v_mfma_f32_32x32x16_bf16 v[160:175], v[52:55], v[184:187], 0
    ds_write_b128 v5, v[224:227] offset:0
    s_cmp_lg_u32 s52, 1
    s_cbranch_scc1 W8_z
    v_mfma_f32_32x32x16_bf16 v[144:159], v[48:51], v[184:187], v[8:23]
    s_branch W8_y
W8_z:
    v_mfma_f32_32x32x16_bf16 v[144:159], v[48:51], v[184:187], 0
W8_y:
    v_mov_b32 v2, v184
    s_add_u32 s42, s50, 88064
    buffer_load_dwordx4 v[200:203], v1, s[8:11], s42 offen offset:2048 sc1
    s_waitcnt vmcnt(3)
    v_mfma_f32_32x32x16_bf16 v[160:175], v[60:63], v[188:191], v[160:175]
    ds_write_b128 v5, v[228:231] offset:1056
    v_mfma_f32_32x32x16_bf16 v[144:159], v[56:59], v[188:191], v[144:159]
    v_and_b32 v2, v2, v188
    s_add_u32 s42, s50, 88064
    buffer_load_dwordx4 v[204:207], v1, s[8:11], s42 offen offset:3072 sc1
    s_waitcnt vmcnt(3)
    v_mfma_f32_32x32x16_bf16 v[160:175], v[68:71], v[192:195], v[160:175]
    ds_write_b128 v5, v[232:235] offset:2112
    v_mfma_f32_32x32x16_bf16 v[144:159], v[64:67], v[192:195], v[144:159]
    v_and_b32 v2, v2, v192
    s_add_u32 s42, s50, 92160
    buffer_load_dwordx4 v[208:211], v1, s[8:11], s42 offen offset:0 sc1
    s_waitcnt vmcnt(3)
    v_mfma_f32_32x32x16_bf16 v[160:175], v[76:79], v[196:199], v[160:175]
    ds_write_b128 v5, v[236:239] offset:3168
    v_mfma_f32_32x32x16_bf16 v[144:159], v[72:75], v[196:199], v[144:159]
    v_and_b32 v2, v2, v196
    s_add_u32 s42, s50, 92160
    buffer_load_dwordx4 v[212:215], v1, s[8:11], s42 offen offset:1024 sc1
    s_waitcnt vmcnt(3)
    v_mfma_f32_32x32x16_bf16 v[160:175], v[84:87], v[200:203], v[160:175]
    v_mfma_f32_32x32x16_bf16 v[144:159], v[80:83], v[200:203], v[144:159]
    v_and_b32 v2, v2, v200
    s_add_u32 s42, s50, 92160
    buffer_load_dwordx4 v[216:219], v1, s[8:11], s42 offen offset:2048 sc1
    s_waitcnt vmcnt(3)
    v_mfma_f32_32x32x16_bf16 v[160:175], v[92:95], v[204:207], v[160:175]
    v_mfma_f32_32x32x16_bf16 v[144:159], v[88:91], v[204:207], v[144:159]
    v_and_b32 v2, v2, v204
    s_add_u32 s42, s50, 92160
    buffer_load_dwordx4 v[220:223], v1, s[8:11], s42 offen offset:3072 sc1
    s_cmp_gt_u32 s51, 1
    s_cbranch_scc1 W8_m1
    v_mfma_f32_32x32x16_bf16 v[160:175], v[44:47], v[180:183], v[160:175]
    v_mfma_f32_32x32x16_bf16 v[144:159], v[40:43], v[180:183], v[144:159]
    v_and_b32 v2, v2, v180
W8_m1:
    s_cmp_gt_u32 s51, 0
    s_cbranch_scc1 W8_m0
    v_mfma_f32_32x32x16_bf16 v[160:175], v[36:39], v[176:179], v[160:175]
    v_mfma_f32_32x32x16_bf16 v[144:159], v[32:35], v[176:179], v[144:159]
    v_and_b32 v2, v2, v176
W8_m0:
    s_waitcnt vmcnt(3)
    v_mfma_f32_32x32x16_bf16 v[160:175], v[100:103], v[208:211], v[160:175]
    v_and_b32 v2, v2, v208
    s_waitcnt vmcnt(2)
    v_mfma_f32_32x32x16_bf16 v[160:175], v[108:111], v[212:215], v[160:175]
    v_and_b32 v2, v2, v212
    s_waitcnt vmcnt(1)
    v_mfma_f32_32x32x16_bf16 v[160:175], v[116:119], v[216:219], v[160:175]
    v_and_b32 v2, v2, v216
    s_waitcnt vmcnt(0)
    v_mfma_f32_32x32x16_bf16 v[160:175], v[124:127], v[220:223], v[160:175]
    v_and_b32 v2, v2, v220
    v_mfma_f32_32x32x16_bf16 v[144:159], v[96:99], v[208:211], v[144:159]
    v_mfma_f32_32x32x16_bf16 v[144:159], v[104:107], v[212:215], v[144:159]
    v_mfma_f32_32x32x16_bf16 v[144:159], v[112:115], v[216:219], v[144:159]
    s_nop 7
    ds_write_b128 v3, v[160:163] offset:0
    ds_write_b128 v3, v[164:167] offset:1056
    v_mfma_f32_32x32x16_bf16 v[144:159], v[120:123], v[220:223], v[144:159]
    ds_write_b128 v3, v[168:171] offset:2112
    ds_write_b128 v3, v[172:175] offset:3168
W8_chk:
    v_and_b32 v2, 1, v2
    v_cmp_ne_u32 vcc, 1, v2
    s_cbranch_vccz W8_ok
    s_cmp_eq_u32 s34, 0
    s_cbranch_scc1 W8_ok
    s_sub_u32 s34, s34, 1
    s_mov_b32 s47, 1
    s_sleep 2
    s_and_b32 s98, s34, 63
    s_cbranch_scc1 W8_again
    v_mov_b32 v2, s34
    buffer_store_dword v2, off, s[8:11], s96 sc1
    s_branch W8_again
W8_ok:
    s_branch W4_join
A5_idle:
    s_sleep 34
    s_branch A5_ld
W5_again:
    s_add_u32 s42, s62, 0
    s_cmp_gt_u32 s51, 0
    s_cbranch_scc1 W5r_i00
    buffer_load_dwordx4 v[128:131], v1, s[8:11], s42 offen offset:0 sc1
W5r_i00:
    s_cmp_gt_u32 s51, 1
    s_cbranch_scc1 W5r_i01
    buffer_load_dwordx4 v[132:135], v1, s[8:11], s42 offen offset:1024 sc1
W5r_i01:
    buffer_load_dwordx4 v[136:139], v1, s[8:11], s42 offen offset:2048 sc1
    buffer_load_dwordx4 v[140:143], v1, s[8:11], s42 offen offset:3072 sc1
    s_add_u32 s42, s50, 0
    buffer_load_dwordx4 v[144:147], v1, s[8:11], s42 offen offset:0 sc1
    buffer_load_dwordx4 v[148:151], v1, s[8:11], s42 offen offset:1024 sc1
    buffer_load_dwordx4 v[152:155], v1, s[8:11], s42 offen offset:2048 sc1
    buffer_load_dwordx4 v[156:159], v1, s[8:11], s42 offen offset:3072 sc1
    s_add_u32 s42, s50, 4096
    buffer_load_dwordx4 v[160:163], v1, s[8:11], s42 offen offset:0 sc1
    buffer_load_dwordx4 v[164:167], v1, s[8:11], s42 offen offset:1024 sc1
    buffer_load_dwordx4 v[168:171], v1, s[8:11], s42 offen offset:2048 sc1
    buffer_load_dwordx4 v[172:175], v1, s[8:11], s42 offen offset:3072 sc1
    s_waitcnt vmcnt(0)
    s_branch W5_body
W8_again:
    s_add_u32 s42, s62, 88064
    s_cmp_gt_u32 s51, 0
    s_cbranch_scc1 W8r_i10
    buffer_load_dwordx4 v[176:179], v1, s[8:11], s42 offen offset:0 sc1
W8r_i10:
    s_cmp_gt_u32 s51, 1
    s_cbranch_scc1 W8r_i11
    buffer_load_dwordx4 v[180:183], v1, s[8:11], s42 offen offset:1024 sc1
W8r_i11:
    buffer_load_dwordx4 v[184:187], v1, s[8:11], s42 offen offset:2048 sc1
    buffer_load_dwordx4 v[188:191], v1, s[8:11], s42 offen offset:3072 sc1
    s_add_u32 s42, s50, 88064
    buffer_load_dwordx4 v[192:195], v1, s[8:11], s42 offen offset:0 sc1
    buffer_load_dwordx4 v[196:199], v1, s[8:11], s42 offen offset:1024 sc1
    buffer_load_dwordx4 v[200:203], v1, s[8:11], s42 offen offset:2048 sc1
    buffer_load_dwordx4 v[204:207], v1, s[8:11], s42 offen offset:3072 sc1
    s_add_u32 s42, s50, 92160
    buffer_load_dwordx4 v[208:211], v1, s[8:11], s42 offen offset:0 sc1
    buffer_load_dwordx4 v[212:215], v1, s[8:11], s42 offen offset:1024 sc1
    buffer_load_dwordx4 v[216:219], v1, s[8:11], s42 offen offset:2048 sc1
    buffer_load_dwordx4 v[220:223], v1, s[8:11], s42 offen offset:3072 sc1
    s_waitcnt vmcnt(0)
    v_mfma_f32_32x32x16_bf16 v[160:175], v[52:55], v[184:187], 0
    s_cmp_lg_u32 s52, 1
    s_cbranch_scc1 W8r_z
    v_mfma_f32_32x32x16_bf16 v[144:159], v[48:51], v[184:187], v[8:23]
    s_branch W8r_y
W8r_z:
    v_mfma_f32_32x32x16_bf16 v[144:159], v[48:51], v[184:187], 0
W8r_y:
    v_mov_b32 v2, v184
    v_mfma_f32_32x32x16_bf16 v[160:175], v[60:63], v[188:191], v[160:175]
    v_mfma_f32_32x32x16_bf16 v[144:159], v[56:59], v[188:191], v[144:159]
    v_and_b32 v2, v2, v188
    v_mfma_f32_32x32x16_bf16 v[160:175], v[68:71], v[192:195], v[160:175]
    v_mfma_f32_32x32x16_bf16 v[144:159], v[64:67], v[192:195], v[144:159]
    v_and_b32 v2, v2, v192
    v_mfma_f32_32x32x16_bf16 v[160:175], v[76:79], v[196:199], v[160:175]
    v_mfma_f32_32x32x16_bf16 v[144:159], v[72:75], v[196:199], v[144:159]
    v_and_b32 v2, v2, v196
    v_mfma_f32_32x32x16_bf16 v[160:175], v[84:87], v[200:203], v[160:175]
    v_mfma_f32_32x32x16_bf16 v[144:159], v[80:83], v[200:203], v[144:159]
    v_and_b32 v2, v2, v200
    v_mfma_f32_32x32x16_bf16 v[160:175], v[92:95], v[204:207], v[160:175]
    v_mfma_f32_32x32x16_bf16 v[144:159], v[88:91], v[204:207], v[144:159]
    v_and_b32 v2, v2, v204
    s_cmp_gt_u32 s51, 1
    s_cbranch_scc1 W8r_m1
    v_mfma_f32_32x32x16_bf16 v[160:175], v[44:47], v[180:183], v[160:175]
    v_mfma_f32_32x32x16_bf16 v[144:159], v[40:43], v[180:183], v[144:159]
    v_and_b32 v2, v2, v180
W8r_m1:
    s_cmp_gt_u32 s51, 0
    s_cbranch_scc1 W8r_m0
    v_mfma_f32_32x32x16_bf16 v[160:175], v[36:39], v[176:179], v[160:175]
    v_mfma_f32_32x32x16_bf16 v[144:159], v[32:35], v[176:179], v[144:159]
    v_and_b32 v2, v2, v176
W8r_m0:
    v_mfma_f32_32x32x16_bf16 v[160:175], v[100:103], v[208:211], v[160:175]
    v_and_b32 v2, v2, v208
    v_mfma_f32_32x32x16_bf16 v[160:175], v[108:111], v[212:215], v[160:175]
    v_and_b32 v2, v2, v212
    v_mfma_f32_32x32x16_bf16 v[160:175], v[116:119], v[216:219], v[160:175]
    v_and_b32 v2, v2, v216
    v_mfma_f32_32x32x16_bf16 v[160:175], v[124:127], v[220:223], v[160:175]
    v_and_b32 v2, v2, v220
    v_mfma_f32_32x32x16_bf16 v[144:159], v[96:99], v[208:211], v[144:159]
    v_mfma_f32_32x32x16_bf16 v[144:159], v[104:107], v[212:215], v[144:159]
    v_mfma_f32_32x32x16_bf16 v[144:159], v[112:115], v[216:219], v[144:159]
    s_nop 7
    ds_write_b128 v3, v[160:163] offset:0
    ds_write_b128 v3, v[164:167] offset:1056
    v_mfma_f32_32x32x16_bf16 v[144:159], v[120:123], v[220:223], v[144:159]
    ds_write_b128 v3, v[168:171] offset:2112
    ds_write_b128 v3, v[172:175] offset:3168
    s_branch W8_chk
A4_again:
    v_and_b32 v60, 0x380, v1
    v_add_u32 v60, v60, v1
    s_lshl_b32 s43, s35, 12
    s_lshl_b32 s42, s31, 7
    s_add_u32 s43, s43, s42
    s_add_u32 s43, s43, s36
    s_add_u32 s43, s43, 0x32000
    buffer_load_dwordx4 v[52:55], v60, s[8:11], s43 offen offset:0 sc1
    buffer_load_dwordx4 v[56:59], v60, s[8:11], s43 offen offset:2048 sc1
    s_mov_b32 m0, s57
    s_nop 0
    buffer_load_dwordx4 v1, s[8:11], s58 offen offset:0 sc1 lds
    buffer_load_dwordx4 v1, s[8:11], s58 offen offset:1024 sc1 lds
    buffer_load_dwordx4 v1, s[8:11], s58 offen offset:2048 sc1 lds
    buffer_load_dwordx4 v1, s[8:11], s58 offen offset:3072 sc1 lds
    s_add_u32 m0, s57, 4096
    s_nop 0
    buffer_load_dwordx4 v1, s[8:11], s61 offen offset:0 sc1 lds
    buffer_load_dwordx4 v1, s[8:11], s61 offen offset:1024 sc1 lds
    buffer_load_dwordx4 v1, s[8:11], s61 offen offset:2048 sc1 lds
    buffer_load_dwordx4 v1, s[8:11], s61 offen offset:3072 sc1 lds
    s_waitcnt vmcnt(0)
    s_branch A4_body
B_start:
    v_mov_b32 v0, v10
    v_mov_b32 v5, v11
    s_and_b32 s40, s3, 3
    s_lshl_b32 s49, s40, 7
    s_add_u32 s49, s49, 94464
    v_bfe_u32 v2, v1, 4, 4
    v_bfe_u32 v12, v1, 8, 1
    v_cmp_eq_u32 vcc, v2, v12
    v_mov_b32 v12, 0x3f803f80
    s_nop 0
    v_cndmask_b32 v8, 0, v12, vcc
    v_mov_b32 v9, v8
    v_mov_b32 v10, v8
    v_mov_b32 v11, v8
    s_nop 1
    v_mfma_f32_16x16x32_bf16 v[12:15], v[8:11], v[128:131], 0
    v_mfma_f32_16x16x32_bf16 v[12:15], v[8:11], v[132:135], v[12:15]
    v_mfma_f32_16x16x32_bf16 v[12:15], v[8:11], v[136:139], v[12:15]
    v_mfma_f32_16x16x32_bf16 v[12:15], v[8:11], v[140:143], v[12:15]
    v_mfma_f32_16x16x32_bf16 v[12:15], v[8:11], v[144:147], v[12:15]
    v_mfma_f32_16x16x32_bf16 v[12:15], v[8:11], v[148:151], v[12:15]
    v_mfma_f32_16x16x32_bf16 v[12:15], v[8:11], v[152:155], v[12:15]
    v_mfma_f32_16x16x32_bf16 v[12:15], v[8:11], v[156:159], v[12:15]
    v_mfma_f32_16x16x32_bf16 v[12:15], v[8:11], v[192:195], v[12:15]
    v_mfma_f32_16x16x32_bf16 v[12:15], v[8:11], v[196:199], v[12:15]
    v_mfma_f32_16x16x32_bf16 v[12:15], v[8:11], v[200:203], v[12:15]
    v_mfma_f32_16x16x32_bf16 v[12:15], v[8:11], v[204:207], v[12:15]
    v_mfma_f32_16x16x32_bf16 v[12:15], v[8:11], v[208:211], v[12:15]
    v_mfma_f32_16x16x32_bf16 v[12:15], v[8:11], v[212:215], v[12:15]
    v_mfma_f32_16x16x32_bf16 v[12:15], v[8:11], v[216:219], v[12:15]
    v_mfma_f32_16x16x32_bf16 v[12:15], v[8:11], v[220:223], v[12:15]
    v_mfma_f32_16x16x32_bf16 v[12:15], v[8:11], v[160:163], v[12:15]
    v_mfma_f32_16x16x32_bf16 v[12:15], v[8:11], v[164:167], v[12:15]
    v_mfma_f32_16x16x32_bf16 v[12:15], v[8:11], v[168:171], v[12:15]
    v_mfma_f32_16x16x32_bf16 v[12:15], v[8:11], v[172:175], v[12:15]
    v_mfma_f32_16x16x32_bf16 v[12:15], v[8:11], v[176:179], v[12:15]
    v_mfma_f32_16x16x32_bf16 v[12:15], v[8:11], v[180:183], v[12:15]
    v_mfma_f32_16x16x32_bf16 v[12:15], v[8:11], v[184:187], v[12:15]
    v_mfma_f32_16x16x32_bf16 v[12:15], v[8:11], v[188:191], v[12:15]
    v_mfma_f32_16x16x32_bf16 v[12:15], v[8:11], v[224:227], v[12:15]
    v_mfma_f32_16x16x32_bf16 v[12:15], v[8:11], v[228:231], v[12:15]
    v_mfma_f32_16x16x32_bf16 v[12:15], v[8:11], v[232:235], v[12:15]
    v_mfma_f32_16x16x32_bf16 v[12:15], v[8:11], v[236:239], v[12:15]
    v_mfma_f32_16x16x32_bf16 v[12:15], v[8:11], v[240:243], v[12:15]
    v_mfma_f32_16x16x32_bf16 v[12:15], v[8:11], v[244:247], v[12:15]
    v_mfma_f32_16x16x32_bf16 v[12:15], v[8:11], v[248:251], v[12:15]
    v_mfma_f32_16x16x32_bf16 v[12:15], v[8:11], v[252:255], v[12:15]
    v_add_u32 v7, 98304, v6
    s_waitcnt vmcnt(0) lgkmcnt(0)
    s_barrier
    v_lshrrev_b32 v2, 2, v1
    v_add_u32 v2, s49, v2
    s_mov_b64 exec, 0xffff
    s_nop 1
    ds_write_b32 v2, v12
    ds_write_b32 v2, v13 offset:64
    s_mov_b64 exec, -1
    s_cmp_lt_u32 s40, 2
    s_cbranch_scc0 B_nocs
    ds_read_b64_tr_b16 v[24:25], v7 offset:0
    ds_read_b64_tr_b16 v[26:27], v7 offset:1024
    ds_read_b64_tr_b16 v[28:29], v7 offset:2048
    ds_read_b64_tr_b16 v[30:31], v7 offset:3072
    ds_read_b64_tr_b16 v[32:33], v7 offset:4096
    ds_read_b64_tr_b16 v[34:35], v7 offset:5120
    ds_read_b64_tr_b16 v[36:37], v7 offset:6144
    ds_read_b64_tr_b16 v[38:39], v7 offset:7168
    ds_read_b64_tr_b16 v[40:41], v7 offset:8192
    ds_read_b64_tr_b16 v[42:43], v7 offset:9216
    ds_read_b64_tr_b16 v[44:45], v7 offset:10240
    ds_read_b64_tr_b16 v[46:47], v7 offset:11264
    ds_read_b64_tr_b16 v[48:49], v7 offset:12288
    ds_read_b64_tr_b16 v[50:51], v7 offset:13312
    ds_read_b64_tr_b16 v[52:53], v7 offset:14336
    ds_read_b64_tr_b16 v[54:55], v7 offset:15360
    ds_read_b64_tr_b16 v[56:57], v7 offset:16384
    ds_read_b64_tr_b16 v[58:59], v7 offset:17408
    ds_read_b64_tr_b16 v[60:61], v7 offset:18432
    ds_read_b64_tr_b16 v[62:63], v7 offset:19456
    ds_read_b64_tr_b16 v[64:65], v7 offset:20480
    ds_read_b64_tr_b16 v[66:67], v7 offset:21504
    ds_read_b64_tr_b16 v[68:69], v7 offset:22528
    ds_read_b64_tr_b16 v[70:71], v7 offset:23552
    ds_read_b64_tr_b16 v[72:73], v7 offset:24576
    ds_read_b64_tr_b16 v[74:75], v7 offset:25600
    ds_read_b64_tr_b16 v[76:77], v7 offset:26624
    ds_read_b64_tr_b16 v[78:79], v7 offset:27648
    ds_read_b64_tr_b16 v[80:81], v7 offset:28672
    ds_read_b64_tr_b16 v[82:83], v7 offset:29696
    ds_read_b64_tr_b16 v[84:85], v7 offset:30720
    ds_read_b64_tr_b16 v[86:87], v7 offset:31744
    s_waitcnt lgkmcnt(15)
    v_mfma_f32_16x16x32_bf16 v[12:15], v[8:11], v[24:27], 0
    v_mfma_f32_16x16x32_bf16 v[12:15], v[8:11], v[28:31], v[12:15]
    v_mfma_f32_16x16x32_bf16 v[12:15], v[8:11], v[32:35], v[12:15]
    v_mfma_f32_16x16x32_bf16 v[12:15], v[8:11], v[36:39], v[12:15]
    v_mfma_f32_16x16x32_bf16 v[12:15], v[8:11], v[40:43], v[12:15]
    v_mfma_f32_16x16x32_bf16 v[12:15], v[8:11], v[44:47], v[12:15]
    v_mfma_f32_16x16x32_bf16 v[12:15], v[8:11], v[48:51], v[12:15]
    v_mfma_f32_16x16x32_bf16 v[12:15], v[8:11], v[52:55], v[12:15]
    s_waitcnt lgkmcnt(14)
    v_mfma_f32_16x16x32_bf16 v[12:15], v[8:11], v[56:59], v[12:15]
    s_waitcnt lgkmcnt(12)
    v_mfma_f32_16x16x32_bf16 v[12:15], v[8:11], v[60:63], v[12:15]
    s_waitcnt lgkmcnt(10)
    v_mfma_f32_16x16x32_bf16 v[12:15], v[8:11], v[64:67], v[12:15]
    s_waitcnt lgkmcnt(8)
    v_mfma_f32_16x16x32_bf16 v[12:15], v[8:11], v[68:71], v[12:15]
    s_waitcnt lgkmcnt(6)
    v_mfma_f32_16x16x32_bf16 v[12:15], v[8:11], v[72:75], v[12:15]
    s_waitcnt lgkmcnt(4)
    v_mfma_f32_16x16x32_bf16 v[12:15], v[8:11], v[76:79], v[12:15]
    s_waitcnt lgkmcnt(2)
    v_mfma_f32_16x16x32_bf16 v[12:15], v[8:11], v[80:83], v[12:15]
    s_waitcnt lgkmcnt(0)
    v_mfma_f32_16x16x32_bf16 v[12:15], v[8:11], v[84:87], v[12:15]
    ds_read_b64_tr_b16 v[24:25], v7 offset:32768
    ds_read_b64_tr_b16 v[26:27], v7 offset:33792
    ds_read_b64_tr_b16 v[28:29], v7 offset:34816
    ds_read_b64_tr_b16 v[30:31], v7 offset:35840
    ds_read_b64_tr_b16 v[32:33], v7 offset:36864
    ds_read_b64_tr_b16 v[34:35], v7 offset:37888
    ds_read_b64_tr_b16 v[36:37], v7 offset:38912
    ds_read_b64_tr_b16 v[38:39], v7 offset:39936
    ds_read_b64_tr_b16 v[40:41], v7 offset:40960
    ds_read_b64_tr_b16 v[42:43], v7 offset:41984
    ds_read_b64_tr_b16 v[44:45], v7 offset:43008
    ds_read_b64_tr_b16 v[46:47], v7 offset:44032
    ds_read_b64_tr_b16 v[48:49], v7 offset:45056
    ds_read_b64_tr_b16 v[50:51], v7 offset:46080
    ds_read_b64_tr_b16 v[52:53], v7 offset:47104
    ds_read_b64_tr_b16 v[54:55], v7 offset:48128
    ds_read_b64_tr_b16 v[56:57], v7 offset:49152
    ds_read_b64_tr_b16 v[58:59], v7 offset:50176
    ds_read_b64_tr_b16 v[60:61], v7 offset:51200
    ds_read_b64_tr_b16 v[62:63], v7 offset:52224
    ds_read_b64_tr_b16 v[64:65], v7 offset:53248
    ds_read_b64_tr_b16 v[66:67], v7 offset:54272
    ds_read_b64_tr_b16 v[68:69], v7 offset:55296
    ds_read_b64_tr_b16 v[70:71], v7 offset:56320
    ds_read_b64_tr_b16 v[72:73], v7 offset:57344
    ds_read_b64_tr_b16 v[74:75], v7 offset:58368
    ds_read_b64_tr_b16 v[76:77], v7 offset:59392
    ds_read_b64_tr_b16 v[78:79], v7 offset:60416
    ds_read_b64_tr_b16 v[80:81], v7 offset:61440
    ds_read_b64_tr_b16 v[82:83], v7 offset:62464
    ds_read_b64_tr_b16 v[84:85], v7 offset:63488
    ds_read_b64_tr_b16 v[86:87], v7 offset:64512
    s_waitcnt lgkmcnt(15)
    v_mfma_f32_16x16x32_bf16 v[12:15], v[8:11], v[24:27], v[12:15]
    v_mfma_f32_16x16x32_bf16 v[12:15], v[8:11], v[28:31], v[12:15]
    v_mfma_f32_16x16x32_bf16 v[12:15], v[8:11], v[32:35], v[12:15]
    v_mfma_f32_16x16x32_bf16 v[12:15], v[8:11], v[36:39], v[12:15]
    v_mfma_f32_16x16x32_bf16 v[12:15], v[8:11], v[40:43], v[12:15]
    v_mfma_f32_16x16x32_bf16 v[12:15], v[8:11], v[44:47], v[12:15]
    v_mfma_f32_16x16x32_bf16 v[12:15], v[8:11], v[48:51], v[12:15]
    v_mfma_f32_16x16x32_bf16 v[12:15], v[8:11], v[52:55], v[12:15]
    s_waitcnt lgkmcnt(14)
    v_mfma_f32_16x16x32_bf16 v[12:15], v[8:11], v[56:59], v[12:15]
    s_waitcnt lgkmcnt(12)
    v_mfma_f32_16x16x32_bf16 v[12:15], v[8:11], v[60:63], v[12:15]
    s_waitcnt lgkmcnt(10)
    v_mfma_f32_16x16x32_bf16 v[12:15], v[8:11], v[64:67], v[12:15]
    s_waitcnt lgkmcnt(8)
    v_mfma_f32_16x16x32_bf16 v[12:15], v[8:11], v[68:71], v[12:15]
    s_waitcnt lgkmcnt(6)
    v_mfma_f32_16x16x32_bf16 v[12:15], v[8:11], v[72:75], v[12:15]
    s_waitcnt lgkmcnt(4)
    v_mfma_f32_16x16x32_bf16 v[12:15], v[8:11], v[76:79], v[12:15]
    s_waitcnt lgkmcnt(2)
    v_mfma_f32_16x16x32_bf16 v[12:15], v[8:11], v[80:83], v[12:15]
    s_waitcnt lgkmcnt(0)
    v_mfma_f32_16x16x32_bf16 v[12:15], v[8:11], v[84:87], v[12:15]
    s_sub_u32 s42, s49, 256
    v_lshrrev_b32 v2, 2, v1
    v_add_u32 v2, s42, v2
    s_mov_b64 exec, 0xffff
    s_nop 3
    ds_write_b32 v2, v12
    ds_write_b32 v2, v13 offset:64
    s_mov_b64 exec, -1
B_nocs:
    s_mul_i32 s50, s40, 10240
    s_add_u32 s50, s50, s36
    s_add_u32 s62, s50, 45056
    s_add_u32 s50, s50, 49152
    s_mov_b32 s51, 2
    s_mov_b32 s52, -1
    s_mov_b32 s47, 0
    s_mul_i32 s60, s40, 163840
    s_lshl_b32 s42, s30, 7
    s_add_u32 s60, s60, s42
    s_add_u32 s61, s60, 753664
    s_add_u32 s60, s60, 786432
    s_mul_i32 s59, s40, 352256
    s_lshl_b32 s42, s37, 6
    s_add_u32 s59, s59, s42
    s_add_u32 s59, s59, 256
    s_lshl_b32 s41, s40, 14
    v_add_u32 v7, s41, v7
    s_add_u32 s41, s41, 98304
    s_lshl_b32 s42, s30, 2
    s_add_u32 s42, s42, s40
    s_lshl_b32 s42, s42, 11
    s_add_u32 s42, s42, s36
    s_mov_b32 s55, s42
    s_add_u32 s56, s55, 88064
    s_add_u32 m0, s41, 8192
    v_and_b32 v16, 0x380, v1
    v_add_u32 v16, v16, v1
    s_lshl_b32 s43, s35, 12
    s_lshl_b32 s42, s31, 7
    s_add_u32 s43, s43, s42
    s_add_u32 s43, s43, s36
    s_add_u32 s43, s43, 0x30000
    s_waitcnt lgkmcnt(0)
    s_barrier
    s_barrier
    buffer_load_dwordx4 v[8:11], v16, s[8:11], s43 offen offset:0 sc1
    buffer_load_dwordx4 v[12:15], v16, s[8:11], s43 offen offset:2048 sc1
    buffer_load_dwordx4 v0, s[24:27], s60 offen lds
    s_add_u32 m0, m0, 1024
    s_add_u32 s60, s60, 8192
    buffer_load_dwordx4 v0, s[24:27], s60 offen lds
    s_add_u32 m0, m0, 1024
    s_add_u32 s60, s60, 8192
    buffer_load_dwordx4 v0, s[24:27], s60 offen lds
    s_add_u32 m0, m0, 1024
    s_add_u32 s60, s60, 8192
    buffer_load_dwordx4 v0, s[24:27], s60 offen lds
    s_add_u32 m0, m0, 1024
    s_add_u32 s60, s60, 8192
    buffer_load_dwordx4 v0, s[24:27], s60 offen lds
    s_add_u32 m0, m0, 1024
    s_add_u32 s60, s60, 8192
    buffer_load_dwordx4 v0, s[24:27], s60 offen lds
    s_add_u32 m0, m0, 1024
    s_add_u32 s60, s60, 8192
    buffer_load_dwordx4 v0, s[24:27], s60 offen lds
    s_add_u32 m0, m0, 1024
    s_add_u32 s60, s60, 8192
    buffer_load_dwordx4 v0, s[24:27], s60 offen lds
    s_waitcnt vmcnt(8)
B2_body:
    v_or3_b32 v2, v8, v9, 0
    v_or3_b32 v2, v10, v11, v2
    v_or3_b32 v2, v12, v13, v2
    v_or3_b32 v2, v14, v15, v2
    v_and_b32 v2, 1, v2
    v_cmp_ne_u32 vcc, 0, v2
    s_cbranch_vccz B2_ok
    s_cmp_eq_u32 s34, 0
    s_cbranch_scc1 B2_ok
    s_sub_u32 s34, s34, 1
    s_mov_b32 s47, 1
    s_sleep 2
    s_and_b32 s98, s34, 63
    s_cbranch_scc1 B2_again
    v_mov_b32 v2, s34
    buffer_store_dword v2, off, s[8:11], s96 sc1
    s_branch B2_again
B2_ok:
    v_add_f32 v8, v8, v12
    v_add_f32 v9, v9, v13
    v_add_f32 v10, v10, v14
    v_add_f32 v11, v11, v15
    s_and_b32 s42, s3, 3
    s_lshl_b32 s42, s42, 8
    s_add_u32 s42, s42, 95232
    v_and_b32 v16, 0x70, v1
    v_permlane32_swap_b32 v8, v10
    v_permlane32_swap_b32 v9, v11
    v_add_f32 v8, v8, v10
    v_add_f32 v9, v9, v11
    v_lshl_add_u32 v16, v4, 3, v16
    v_lshlrev_b32 v16, 1, v16
    v_permlane16_swap_b32 v8, v9
    v_add_f32 v8, v8, v9
    v_add_u32 v16, s42, v16
    s_nop 0
    v_add_f32_dpp v8, v8, v8 row_ror:8 row_mask:0xf bank_mask:0xf
    v_mul_f32 v8, 0x3b000000, v8
    v_mov_b32 v9, v8
    s_nop 1
    v_permlane16_swap_b32 v8, v9
    v_fma_f32 v9, -v8, v8, v9
    v_max_f32 v9, 0, v9
    v_add_f32 v11, 0x3727c5ac, v9
    v_rsq_f32 v10, v11
    s_nop 0
    v_mul_f32 v11, -v8, v10
    v_mul_f32 v8, v10, v10
    v_fmaak_f32 v8, v8, v9, 0x3727c5ac
    v_rsq_f32 v8, v8
    s_nop 0
    v_mul_f32 v9, v11, v8
    v_mul_f32 v8, v10, v8
    ds_write_b128 v16, v[8:11]
    s_waitcnt lgkmcnt(0)
    s_barrier
    s_add_u32 m0, s41, 4096
    s_nop 0
    buffer_load_dwordx4 v0, s[24:27], s61 offen lds
    s_add_u32 m0, m0, 1024
    s_add_u32 s61, s61, 8192
    buffer_load_dwordx4 v0, s[24:27], s61 offen lds
    s_add_u32 m0, m0, 1024
    s_add_u32 s61, s61, 8192
    buffer_load_dwordx4 v0, s[24:27], s61 offen lds
    s_add_u32 m0, m0, 1024
    s_add_u32 s61, s61, 8192
    buffer_load_dwordx4 v0, s[24:27], s61 offen lds
    s_mov_b32 m0, s41
    s_nop 0
    buffer_load_dwordx4 v5, s[20:23], s59 offen lds
    s_add_u32 m0, m0, 1024
    s_add_u32 s59, s59, 22016
    buffer_load_dwordx4 v5, s[20:23], s59 offen lds
    s_add_u32 m0, m0, 1024
    s_add_u32 s59, s59, 22016
    buffer_load_dwordx4 v5, s[20:23], s59 offen lds
    s_add_u32 m0, m0, 1024
    s_add_u32 s59, s59, 22016
    buffer_load_dwordx4 v5, s[20:23], s59 offen lds
    v_xor_b32 v2, 64, v7
    s_waitcnt vmcnt(4)
    ds_read_b64_tr_b16 v[48:49], v7 offset:4096
    ds_read_b64_tr_b16 v[50:51], v7 offset:5120
    ds_read_b64_tr_b16 v[52:53], v2 offset:4096
    ds_read_b64_tr_b16 v[54:55], v2 offset:5120
    ds_read_b64_tr_b16 v[56:57], v7 offset:6144
    ds_read_b64_tr_b16 v[58:59], v7 offset:7168
    ds_read_b64_tr_b16 v[60:61], v2 offset:6144
    ds_read_b64_tr_b16 v[62:63], v2 offset:7168
    ds_read_b64_tr_b16 v[64:65], v7 offset:8192
    ds_read_b64_tr_b16 v[66:67], v7 offset:9216
    ds_read_b64_tr_b16 v[68:69], v2 offset:8192
    ds_read_b64_tr_b16 v[70:71], v2 offset:9216
    ds_read_b64_tr_b16 v[72:73], v7 offset:10240
    ds_read_b64_tr_b16 v[74:75], v7 offset:11264
    ds_read_b64_tr_b16 v[76:77], v2 offset:10240
    ds_read_b64_tr_b16 v[78:79], v2 offset:11264
    ds_read_b64_tr_b16 v[80:81], v7 offset:12288
    ds_read_b64_tr_b16 v[82:83], v7 offset:13312
    ds_read_b64_tr_b16 v[84:85], v2 offset:12288
    ds_read_b64_tr_b16 v[86:87], v2 offset:13312
    ds_read_b64_tr_b16 v[88:89], v7 offset:14336
    ds_read_b64_tr_b16 v[90:91], v7 offset:15360
    ds_read_b64_tr_b16 v[92:93], v2 offset:14336
    ds_read_b64_tr_b16 v[94:95], v2 offset:15360
    s_waitcnt lgkmcnt(0)
    s_barrier
    s_add_u32 m0, m0, 1024
    s_add_u32 s59, s59, 22016
    buffer_load_dwordx4 v5, s[20:23], s59 offen lds
    s_add_u32 m0, m0, 1024
    s_add_u32 s59, s59, 22016
    buffer_load_dwordx4 v5, s[20:23], s59 offen lds
    s_add_u32 m0, m0, 1024
    s_add_u32 s59, s59, 22016
    buffer_load_dwordx4 v5, s[20:23], s59 offen lds
    s_add_u32 m0, m0, 1024
    s_add_u32 s59, s59, 22016
    buffer_load_dwordx4 v5, s[20:23], s59 offen lds
    s_add_u32 m0, m0, 1024
    s_add_u32 s59, s59, 22016
    buffer_load_dwordx4 v5, s[20:23], s59 offen lds
    s_add_u32 m0, m0, 1024
    s_add_u32 s59, s59, 22016
    buffer_load_dwordx4 v5, s[20:23], s59 offen lds
    s_add_u32 m0, m0, 1024
    s_add_u32 s59, s59, 22016
    buffer_load_dwordx4 v5, s[20:23], s59 offen lds
    s_add_u32 m0, m0, 1024
    s_add_u32 s59, s59, 22016
    buffer_load_dwordx4 v5, s[20:23], s59 offen lds
    s_add_u32 m0, m0, 1024
    s_add_u32 s59, s59, 22016
    buffer_load_dwordx4 v5, s[20:23], s59 offen lds
    s_add_u32 m0, m0, 1024
    s_add_u32 s59, s59, 22016
    buffer_load_dwordx4 v5, s[20:23], s59 offen lds
    s_add_u32 m0, m0, 1024
    s_add_u32 s59, s59, 22016
    buffer_load_dwordx4 v5, s[20:23], s59 offen lds
    s_add_u32 m0, m0, 1024
    s_add_u32 s59, s59, 22016
    buffer_load_dwordx4 v5, s[20:23], s59 offen lds
    s_barrier
    s_mul_i32 m0, s40, 16384
    s_lshl_b32 s60, m0, 3
    s_lshl_b32 s42, s30, 7
    s_add_u32 s60, s60, s42
    buffer_load_dwordx4 v0, s[24:27], s60 offen lds
    s_add_u32 m0, m0, 1024
    s_add_u32 s60, s60, 8192
    buffer_load_dwordx4 v0, s[24:27], s60 offen lds
    s_add_u32 m0, m0, 1024
    s_add_u32 s60, s60, 8192
    buffer_load_dwordx4 v0, s[24:27], s60 offen lds
    s_add_u32 m0, m0, 1024
    s_add_u32 s60, s60, 8192
    buffer_load_dwordx4 v0, s[24:27], s60 offen lds
    s_add_u32 m0, m0, 1024
    s_add_u32 s60, s60, 8192
    buffer_load_dwordx4 v0, s[24:27], s60 offen lds
    s_add_u32 m0, m0, 1024
    s_add_u32 s60, s60, 8192
    buffer_load_dwordx4 v0, s[24:27], s60 offen lds
    s_add_u32 m0, m0, 1024
    s_add_u32 s60, s60, 8192
    buffer_load_dwordx4 v0, s[24:27], s60 offen lds
    s_add_u32 m0, m0, 1024
    s_add_u32 s60, s60, 8192
    buffer_load_dwordx4 v0, s[24:27], s60 offen lds
    s_add_u32 m0, m0, 1024
    s_add_u32 s60, s60, 8192
    buffer_load_dwordx4 v0, s[24:27], s60 offen lds
    s_add_u32 m0, m0, 1024
    s_add_u32 s60, s60, 8192
    buffer_load_dwordx4 v0, s[24:27], s60 offen lds
    s_add_u32 m0, m0, 1024
    s_add_u32 s60, s60, 8192
    buffer_load_dwordx4 v0, s[24:27], s60 offen lds
    s_add_u32 m0, m0, 1024
    s_add_u32 s60, s60, 8192
    buffer_load_dwordx4 v0, s[24:27], s60 offen lds
    s_add_u32 m0, m0, 1024
    s_add_u32 s60, s60, 8192
    buffer_load_dwordx4 v0, s[24:27], s60 offen lds
    s_add_u32 m0, m0, 1024
    s_add_u32 s60, s60, 8192
    buffer_load_dwordx4 v0, s[24:27], s60 offen lds
    s_add_u32 m0, m0, 1024
    s_add_u32 s60, s60, 8192
    buffer_load_dwordx4 v0, s[24:27], s60 offen lds
    s_add_u32 m0, m0, 1024
    s_add_u32 s60, s60, 8192
    buffer_load_dwordx4 v0, s[24:27], s60 offen lds
    s_mul_i32 s60, s40, 7168
    s_add_u32 m0, s60, 65536
    s_lshl_b32 s60, m0, 3
    s_add_u32 s60, s60, s42
    s_xor_b32 s58, s3, 4
    s_lshl_b32 s58, s58, 13
    s_add_u32 s57, s58, 98304
    v_add_u32 v16, s57, v1
    s_add_u32 s58, s58, s36
    s_add_u32 s58, s58, 0x34000
    s_add_u32 s61, s58, 4096
    s_barrier
    s_waitcnt vmcnt(16)
    s_barrier
    buffer_load_dwordx4 v0, s[24:27], s60 offen lds
    s_add_u32 m0, m0, 1024
    s_add_u32 s60, s60, 8192
    buffer_load_dwordx4 v0, s[24:27], s60 offen lds
    s_add_u32 m0, m0, 1024
    s_add_u32 s60, s60, 8192
    buffer_load_dwordx4 v0, s[24:27], s60 offen lds
    s_add_u32 m0, m0, 1024
    s_add_u32 s60, s60, 8192
    buffer_load_dwordx4 v0, s[24:27], s60 offen lds
    s_add_u32 m0, m0, 1024
    s_add_u32 s60, s60, 8192
    buffer_load_dwordx4 v0, s[24:27], s60 offen lds
    s_add_u32 m0, m0, 1024
    s_add_u32 s60, s60, 8192
    buffer_load_dwordx4 v0, s[24:27], s60 offen lds
    s_add_u32 m0, m0, 1024
    s_add_u32 s60, s60, 8192
    buffer_load_dwordx4 v0, s[24:27], s60 offen lds
    s_setprio 3
    s_waitcnt vmcnt(7)
    s_barrier
B4_again:
    s_mov_b32 m0, s57
    s_nop 0
    buffer_load_dwordx4 v1, s[8:11], s58 offen offset:0 sc1 lds
    buffer_load_dwordx4 v1, s[8:11], s58 offen offset:1024 sc1 lds
    buffer_load_dwordx4 v1, s[8:11], s58 offen offset:2048 sc1 lds
    buffer_load_dwordx4 v1, s[8:11], s58 offen offset:3072 sc1 lds
    s_add_u32 m0, s57, 4096
    s_nop 0
    buffer_load_dwordx4 v1, s[8:11], s61 offen offset:0 sc1 lds
    buffer_load_dwordx4 v1, s[8:11], s61 offen offset:1024 sc1 lds
    buffer_load_dwordx4 v1, s[8:11], s61 offen offset:2048 sc1 lds
    buffer_load_dwordx4 v1, s[8:11], s61 offen offset:3072 sc1 lds
    v_lshl_add_u32 v5, v4, 4, s49
    v_lshlrev_b32 v7, 4, v3
    v_add_u32 v7, 96256, v7
    s_waitcnt vmcnt(4)
    ds_read_b32 v8, v16 offset:0
    ds_read_b32 v9, v16 offset:1024
    ds_read_b32 v10, v16 offset:2048
    ds_read_b32 v11, v16 offset:3072
    s_waitcnt vmcnt(2)
    ds_read_b32 v12, v16 offset:4096
    ds_read_b32 v13, v16 offset:5120
    s_waitcnt vmcnt(0)
    ds_read_b32 v14, v16 offset:6144
    ds_read_b32 v15, v16 offset:7168
    s_waitcnt lgkmcnt(2)
    v_or3_b32 v2, v8, v9, 0
    v_or3_b32 v2, v10, v11, v2
    v_or3_b32 v2, v12, v13, v2
    s_waitcnt lgkmcnt(0)
    v_or3_b32 v2, v14, v15, v2
    v_and_b32 v2, 1, v2
    v_cmp_ne_u32 vcc, 0, v2
    s_cbranch_vccz B4_ok
    s_cmp_eq_u32 s34, 0
    s_cbranch_scc1 B4_ok
    s_sub_u32 s34, s34, 1
    s_mov_b32 s47, 1
    s_sleep 2
    s_and_b32 s98, s34, 63
    s_cbranch_scc1 B4_again
    v_mov_b32 v2, s34
    buffer_store_dword v2, off, s[8:11], s96 sc1
    s_branch B4_again
B4_ok:
    v_add_u32 v2, 98304, v1
    s_barrier
    ds_read_b128 v[24:27], v2 offset:0
    ds_read_b128 v[28:31], v2 offset:1024
    ds_read_b128 v[32:35], v2 offset:2048
    ds_read_b128 v[36:39], v2 offset:3072
    ds_read_b128 v[40:43], v2 offset:4096
    ds_read_b128 v[44:47], v2 offset:5120
    s_waitcnt lgkmcnt(5)
    v_mfma_f32_32x32x16_bf16 v[8:23], v[128:131], v[24:27], 0
    ds_read_b128 v[24:27], v2 offset:6144
    s_waitcnt lgkmcnt(5)
    v_mfma_f32_32x32x16_bf16 v[8:23], v[132:135], v[28:31], v[8:23]
    ds_read_b128 v[28:31], v2 offset:7168
    s_waitcnt lgkmcnt(5)
    v_mfma_f32_32x32x16_bf16 v[8:23], v[136:139], v[32:35], v[8:23]
    ds_read_b128 v[32:35], v2 offset:8192
    s_waitcnt lgkmcnt(5)
    v_mfma_f32_32x32x16_bf16 v[8:23], v[140:143], v[36:39], v[8:23]
    ds_read_b128 v[36:39], v2 offset:9216
    s_waitcnt lgkmcnt(5)
    v_mfma_f32_32x32x16_bf16 v[8:23], v[144:147], v[40:43], v[8:23]
    ds_read_b128 v[40:43], v2 offset:10240
    s_waitcnt lgkmcnt(5)
    v_mfma_f32_32x32x16_bf16 v[8:23], v[148:151], v[44:47], v[8:23]
    ds_read_b128 v[44:47], v2 offset:11264
    s_waitcnt lgkmcnt(5)
    v_mfma_f32_32x32x16_bf16 v[8:23], v[152:155], v[24:27], v[8:23]
    ds_read_b128 v[24:27], v2 offset:12288
    s_waitcnt lgkmcnt(5)
    v_mfma_f32_32x32x16_bf16 v[8:23], v[156:159], v[28:31], v[8:23]
    ds_read_b128 v[28:31], v2 offset:13312
    s_waitcnt lgkmcnt(5)
    v_mfma_f32_32x32x16_bf16 v[8:23], v[192:195], v[32:35], v[8:23]
    ds_read_b128 v[32:35], v2 offset:14336
    s_waitcnt lgkmcnt(5)
    v_mfma_f32_32x32x16_bf16 v[8:23], v[196:199], v[36:39], v[8:23]
    ds_read_b128 v[36:39], v2 offset:15360
    s_waitcnt lgkmcnt(5)
    v_mfma_f32_32x32x16_bf16 v[8:23], v[200:203], v[40:43], v[8:23]
    ds_read_b128 v[40:43], v2 offset:16384
    s_waitcnt lgkmcnt(5)
    v_mfma_f32_32x32x16_bf16 v[8:23], v[204:207], v[44:47], v[8:23]
    ds_read_b128 v[44:47], v2 offset:17408
    s_waitcnt lgkmcnt(5)
    v_mfma_f32_32x32x16_bf16 v[8:23], v[208:211], v[24:27], v[8:23]
    ds_read_b128 v[24:27], v2 offset:18432
    s_waitcnt lgkmcnt(5)
    v_mfma_f32_32x32x16_bf16 v[8:23], v[212:215], v[28:31], v[8:23]
    ds_read_b128 v[28:31], v2 offset:19456
    s_waitcnt lgkmcnt(5)
    v_mfma_f32_32x32x16_bf16 v[8:23], v[216:219], v[32:35], v[8:23]
    ds_read_b128 v[32:35], v2 offset:20480
    s_waitcnt lgkmcnt(5)
    v_mfma_f32_32x32x16_bf16 v[8:23], v[220:223], v[36:39], v[8:23]
    ds_read_b128 v[36:39], v2 offset:21504
    s_waitcnt lgkmcnt(5)
    v_mfma_f32_32x32x16_bf16 v[8:23], v[160:163], v[40:43], v[8:23]
    ds_read_b128 v[40:43], v2 offset:22528
    s_waitcnt lgkmcnt(5)
    v_mfma_f32_32x32x16_bf16 v[8:23], v[164:167], v[44:47], v[8:23]
    ds_read_b128 v[44:47], v2 offset:23552
    s_waitcnt lgkmcnt(5)
    v_mfma_f32_32x32x16_bf16 v[8:23], v[168:171], v[24:27], v[8:23]
    ds_read_b128 v[24:27], v2 offset:24576
    s_waitcnt lgkmcnt(5)
    v_mfma_f32_32x32x16_bf16 v[8:23], v[172:175], v[28:31], v[8:23]
    ds_read_b128 v[28:31], v2 offset:25600
    s_waitcnt lgkmcnt(5)
    v_mfma_f32_32x32x16_bf16 v[8:23], v[176:179], v[32:35], v[8:23]
    ds_read_b128 v[32:35], v2 offset:26624
    s_waitcnt lgkmcnt(5)
    v_mfma_f32_32x32x16_bf16 v[8:23], v[180:183], v[36:39], v[8:23]
    ds_read_b128 v[36:39], v2 offset:27648
    s_waitcnt lgkmcnt(5)
    v_mfma_f32_32x32x16_bf16 v[8:23], v[184:187], v[40:43], v[8:23]
    ds_read_b128 v[40:43], v2 offset:28672
    s_waitcnt lgkmcnt(5)
    v_mfma_f32_32x32x16_bf16 v[8:23], v[188:191], v[44:47], v[8:23]
    ds_read_b128 v[44:47], v2 offset:29696
    s_waitcnt lgkmcnt(5)
    v_mfma_f32_32x32x16_bf16 v[8:23], v[224:227], v[24:27], v[8:23]
    ds_read_b128 v[24:27], v2 offset:30720
    s_waitcnt lgkmcnt(5)
    v_mfma_f32_32x32x16_bf16 v[8:23], v[228:231], v[28:31], v[8:23]
    ds_read_b128 v[28:31], v2 offset:31744
    s_waitcnt lgkmcnt(5)
    v_mfma_f32_32x32x16_bf16 v[8:23], v[232:235], v[32:35], v[8:23]
    ds_read_b128 v[32:35], v5 offset:0
    s_waitcnt lgkmcnt(5)
    v_mfma_f32_32x32x16_bf16 v[8:23], v[236:239], v[36:39], v[8:23]
    ds_read_b128 v[36:39], v5 offset:32
    s_waitcnt lgkmcnt(5)
    v_mfma_f32_32x32x16_bf16 v[8:23], v[240:243], v[40:43], v[8:23]
    ds_read_b128 v[40:43], v5 offset:64
    s_waitcnt lgkmcnt(5)
    v_mfma_f32_32x32x16_bf16 v[8:23], v[244:247], v[44:47], v[8:23]
    ds_read_b128 v[44:47], v5 offset:96
    s_waitcnt lgkmcnt(5)
    v_mfma_f32_32x32x16_bf16 v[8:23], v[248:251], v[24:27], v[8:23]
    s_waitcnt lgkmcnt(4)
    v_mfma_f32_32x32x16_bf16 v[8:23], v[252:255], v[28:31], v[8:23]
    s_barrier
    ds_read_b128 v[24:27], v7
    s_waitcnt lgkmcnt(0)
    s_nop 8
    v_fmac_f32 v8, v32, v24
    v_fmac_f32 v9, v33, v24
    v_fmac_f32 v10, v34, v24
    v_fmac_f32 v11, v35, v24
    v_fmac_f32 v12, v36, v24
    v_fmac_f32 v13, v37, v24
    v_fmac_f32 v14, v38, v24
    v_fmac_f32 v15, v39, v24
    v_fmac_f32 v16, v40, v24
    v_fmac_f32 v17, v41, v24
    v_fmac_f32 v18, v42, v24
    v_fmac_f32 v19, v43, v24
    v_fmac_f32 v20, v44, v24
    v_fmac_f32 v21, v45, v24
    v_fmac_f32 v22, v46, v24
    v_fmac_f32 v23, v47, v24
    v_mul_f32 v32, v8, v8
    v_mul_f32 v33, v9, v9
    v_mul_f32 v34, v10, v10
    v_mul_f32 v35, v11, v11
    v_mul_f32 v36, v12, v12
    v_mul_f32 v37, v13, v13
    v_mul_f32 v38, v14, v14
    v_mul_f32 v39, v15, v15
    v_mul_f32 v40, v16, v16
    v_mul_f32 v41, v17, v17
    v_mul_f32 v42, v18, v18
    v_mul_f32 v43, v19, v19
    v_mul_f32 v44, v20, v20
    v_mul_f32 v45, v21, v21
    v_mul_f32 v46, v22, v22
    v_mul_f32 v47, v23, v23
    v_fma_f32 v32, v32, v26, v25
    v_fma_f32 v33, v33, v26, v25
    v_fma_f32 v34, v34, v26, v25
    v_fma_f32 v35, v35, v26, v25
    v_fma_f32 v36, v36, v26, v25
    v_fma_f32 v37, v37, v26, v25
    v_fma_f32 v38, v38, v26, v25
    v_fma_f32 v39, v39, v26, v25
    v_fma_f32 v40, v40, v26, v25
    v_fma_f32 v41, v41, v26, v25
    v_fma_f32 v42, v42, v26, v25
    v_fma_f32 v43, v43, v26, v25
    v_fma_f32 v44, v44, v26, v25
    v_fma_f32 v45, v45, v26, v25
    v_fma_f32 v46, v46, v26, v25
    v_fma_f32 v47, v47, v26, v25
    v_mul_f32 v32, v32, v8
    v_mul_f32 v33, v33, v9
    v_mul_f32 v34, v34, v10
    v_mul_f32 v35, v35, v11
    v_mul_f32 v36, v36, v12
    v_mul_f32 v37, v37, v13
    v_mul_f32 v38, v38, v14
    v_mul_f32 v39, v39, v15
    v_mul_f32 v40, v40, v16
    v_mul_f32 v41, v41, v17
    v_mul_f32 v42, v42, v18
    v_mul_f32 v43, v43, v19
    v_mul_f32 v44, v44, v20
    v_mul_f32 v45, v45, v21
    v_mul_f32 v46, v46, v22
    v_mul_f32 v47, v47, v23
    v_exp_f32 v32, v32
    v_exp_f32 v33, v33
    v_exp_f32 v34, v34
    v_exp_f32 v35, v35
    v_exp_f32 v36, v36
    v_exp_f32 v37, v37
    v_exp_f32 v38, v38
    v_exp_f32 v39, v39
    v_exp_f32 v40, v40
    v_exp_f32 v41, v41
    v_exp_f32 v42, v42
    v_exp_f32 v43, v43
    v_exp_f32 v44, v44
    v_exp_f32 v45, v45
    v_exp_f32 v46, v46
    v_exp_f32 v47, v47
    v_fma_f32 v32, v32, v27, v27
    v_fma_f32 v33, v33, v27, v27
    v_fma_f32 v34, v34, v27, v27
    v_fma_f32 v35, v35, v27, v27
    v_fma_f32 v36, v36, v27, v27
    v_fma_f32 v37, v37, v27, v27
    v_fma_f32 v38, v38, v27, v27
    v_fma_f32 v39, v39, v27, v27
    v_fma_f32 v40, v40, v27, v27
    v_fma_f32 v41, v41, v27, v27
    v_fma_f32 v42, v42, v27, v27
    v_fma_f32 v43, v43, v27, v27
    v_fma_f32 v44, v44, v27, v27
    v_fma_f32 v45, v45, v27, v27
    v_fma_f32 v46, v46, v27, v27
    v_fma_f32 v47, v47, v27, v27
    v_rcp_f32 v32, v32
    v_rcp_f32 v33, v33
    v_rcp_f32 v34, v34
    v_rcp_f32 v35, v35
    v_rcp_f32 v36, v36
    v_rcp_f32 v37, v37
    v_rcp_f32 v38, v38
    v_rcp_f32 v39, v39
    v_rcp_f32 v40, v40
    v_rcp_f32 v41, v41
    v_rcp_f32 v42, v42
    v_rcp_f32 v43, v43
    v_rcp_f32 v44, v44
    v_rcp_f32 v45, v45
    v_rcp_f32 v46, v46
    v_rcp_f32 v47, v47
    v_mul_f32 v8, v8, v32
    v_mul_f32 v9, v9, v33
    v_mul_f32 v10, v10, v34
    v_mul_f32 v11, v11, v35
    v_mul_f32 v12, v12, v36
    v_mul_f32 v13, v13, v37
    v_mul_f32 v14, v14, v38
    v_mul_f32 v15, v15, v39
    v_mul_f32 v16, v16, v40
    v_mul_f32 v17, v17, v41
    v_mul_f32 v18, v18, v42
    v_mul_f32 v19, v19, v43
    v_mul_f32 v20, v20, v44
    v_mul_f32 v21, v21, v45
    v_mul_f32 v22, v22, v46
    v_mul_f32 v23, v23, v47
    v_cvt_pk_bf16_f32 v40, v8, v9
    v_cvt_pk_bf16_f32 v44, v16, v17
    v_or_b32_sdwa v40, v8, 1 dst_sel:WORD_0 dst_unused:UNUSED_PRESERVE src0_sel:WORD_1 src1_sel:DWORD
    v_or_b32_sdwa v44, v16, 1 dst_sel:WORD_0 dst_unused:UNUSED_PRESERVE src0_sel:WORD_1 src1_sel:DWORD
    v_cvt_pk_bf16_f32 v41, v10, v11
    v_cvt_pk_bf16_f32 v42, v12, v13
    v_cvt_pk_bf16_f32 v43, v14, v15
    v_cvt_pk_bf16_f32 v45, v18, v19
    v_cvt_pk_bf16_f32 v46, v20, v21
    v_cvt_pk_bf16_f32 v47, v22, v23
    buffer_store_dwordx4 v[40:43], v1, s[8:11], s55 offen sc1
    buffer_store_dwordx4 v[44:47], v1, s[8:11], s55 offen offset:1024 sc1
    s_setprio 1
    v_add_u32 v2, 131072, v1
    ds_read_b128 v[24:27], v2 offset:0
    ds_read_b128 v[28:31], v2 offset:1024
    ds_read_b128 v[32:35], v2 offset:2048
    ds_read_b128 v[36:39], v2 offset:3072
    ds_read_b128 v[40:43], v2 offset:4096
    ds_read_b128 v[44:47], v2 offset:5120
    s_waitcnt lgkmcnt(5)
    v_mfma_f32_32x32x16_bf16 v[8:23], v[128:131], v[24:27], 0
    ds_read_b128 v[24:27], v2 offset:6144
    s_waitcnt lgkmcnt(5)
    v_mfma_f32_32x32x16_bf16 v[8:23], v[132:135], v[28:31], v[8:23]
    ds_read_b128 v[28:31], v2 offset:7168
    s_waitcnt lgkmcnt(5)
    v_mfma_f32_32x32x16_bf16 v[8:23], v[136:139], v[32:35], v[8:23]
    ds_read_b128 v[32:35], v2 offset:8192
    s_waitcnt lgkmcnt(5)
    v_mfma_f32_32x32x16_bf16 v[8:23], v[140:143], v[36:39], v[8:23]
    ds_read_b128 v[36:39], v2 offset:9216
    s_waitcnt lgkmcnt(5)
    v_mfma_f32_32x32x16_bf16 v[8:23], v[144:147], v[40:43], v[8:23]
    ds_read_b128 v[40:43], v2 offset:10240
    s_waitcnt lgkmcnt(5)
    v_mfma_f32_32x32x16_bf16 v[8:23], v[148:151], v[44:47], v[8:23]
    ds_read_b128 v[44:47], v2 offset:11264
    s_waitcnt lgkmcnt(5)
    v_mfma_f32_32x32x16_bf16 v[8:23], v[152:155], v[24:27], v[8:23]
    ds_read_b128 v[24:27], v2 offset:12288
    s_waitcnt lgkmcnt(5)
    v_mfma_f32_32x32x16_bf16 v[8:23], v[156:159], v[28:31], v[8:23]
    ds_read_b128 v[28:31], v2 offset:13312
    s_waitcnt lgkmcnt(5)
    v_mfma_f32_32x32x16_bf16 v[8:23], v[192:195], v[32:35], v[8:23]
    ds_read_b128 v[32:35], v2 offset:14336
    s_waitcnt lgkmcnt(5)
    v_mfma_f32_32x32x16_bf16 v[8:23], v[196:199], v[36:39], v[8:23]
    ds_read_b128 v[36:39], v2 offset:15360
    s_waitcnt lgkmcnt(5)
    v_mfma_f32_32x32x16_bf16 v[8:23], v[200:203], v[40:43], v[8:23]
    ds_read_b128 v[40:43], v2 offset:16384
    s_waitcnt lgkmcnt(5)
    v_mfma_f32_32x32x16_bf16 v[8:23], v[204:207], v[44:47], v[8:23]
    ds_read_b128 v[44:47], v2 offset:17408
    s_waitcnt lgkmcnt(5)
    v_mfma_f32_32x32x16_bf16 v[8:23], v[208:211], v[24:27], v[8:23]
    ds_read_b128 v[24:27], v2 offset:18432
    s_waitcnt lgkmcnt(5)
    v_mfma_f32_32x32x16_bf16 v[8:23], v[212:215], v[28:31], v[8:23]
    ds_read_b128 v[28:31], v2 offset:19456
    s_waitcnt lgkmcnt(5)
    v_mfma_f32_32x32x16_bf16 v[8:23], v[216:219], v[32:35], v[8:23]
    ds_read_b128 v[32:35], v2 offset:20480
    s_waitcnt lgkmcnt(5)
    v_mfma_f32_32x32x16_bf16 v[8:23], v[220:223], v[36:39], v[8:23]
    ds_read_b128 v[36:39], v2 offset:21504
    s_waitcnt lgkmcnt(5)
    v_mfma_f32_32x32x16_bf16 v[8:23], v[160:163], v[40:43], v[8:23]
    ds_read_b128 v[40:43], v2 offset:22528
    s_waitcnt lgkmcnt(5)
    v_mfma_f32_32x32x16_bf16 v[8:23], v[164:167], v[44:47], v[8:23]
    ds_read_b128 v[44:47], v2 offset:23552
    s_waitcnt lgkmcnt(5)
    v_mfma_f32_32x32x16_bf16 v[8:23], v[168:171], v[24:27], v[8:23]
    ds_read_b128 v[24:27], v2 offset:24576
    s_waitcnt lgkmcnt(5)
    v_mfma_f32_32x32x16_bf16 v[8:23], v[172:175], v[28:31], v[8:23]
    ds_read_b128 v[28:31], v2 offset:25600
    s_waitcnt lgkmcnt(5)
    v_mfma_f32_32x32x16_bf16 v[8:23], v[176:179], v[32:35], v[8:23]
    ds_read_b128 v[32:35], v2 offset:26624
    s_waitcnt lgkmcnt(5)
    v_mfma_f32_32x32x16_bf16 v[8:23], v[180:183], v[36:39], v[8:23]
    ds_read_b128 v[36:39], v2 offset:27648
    s_waitcnt lgkmcnt(5)
    v_mfma_f32_32x32x16_bf16 v[8:23], v[184:187], v[40:43], v[8:23]
    ds_read_b128 v[40:43], v2 offset:28672
    s_waitcnt lgkmcnt(5)
    v_mfma_f32_32x32x16_bf16 v[8:23], v[188:191], v[44:47], v[8:23]
    ds_read_b128 v[44:47], v2 offset:29696
    s_waitcnt lgkmcnt(5)
    v_mfma_f32_32x32x16_bf16 v[8:23], v[224:227], v[24:27], v[8:23]
    ds_read_b128 v[24:27], v2 offset:30720
    s_waitcnt lgkmcnt(5)
    v_mfma_f32_32x32x16_bf16 v[8:23], v[228:231], v[28:31], v[8:23]
    ds_read_b128 v[28:31], v2 offset:31744
    s_waitcnt lgkmcnt(5)
    v_mfma_f32_32x32x16_bf16 v[8:23], v[232:235], v[32:35], v[8:23]
    ds_read_b128 v[32:35], v5 offset:0
    s_waitcnt lgkmcnt(5)
    v_mfma_f32_32x32x16_bf16 v[8:23], v[236:239], v[36:39], v[8:23]
    ds_read_b128 v[36:39], v5 offset:32
    s_waitcnt lgkmcnt(5)
    v_mfma_f32_32x32x16_bf16 v[8:23], v[240:243], v[40:43], v[8:23]
    ds_read_b128 v[40:43], v5 offset:64
    s_waitcnt lgkmcnt(5)
    v_mfma_f32_32x32x16_bf16 v[8:23], v[244:247], v[44:47], v[8:23]
    ds_read_b128 v[44:47], v5 offset:96
    s_waitcnt lgkmcnt(5)
    v_mfma_f32_32x32x16_bf16 v[8:23], v[248:251], v[24:27], v[8:23]
    ds_read_b128 v[24:27], v7 offset:512
    s_waitcnt lgkmcnt(5)
    v_mfma_f32_32x32x16_bf16 v[8:23], v[252:255], v[28:31], v[8:23]
    s_waitcnt lgkmcnt(0)
    s_nop 10
    v_fmac_f32 v8, v32, v24
    v_fmac_f32 v9, v33, v24
    v_fmac_f32 v10, v34, v24
    v_fmac_f32 v11, v35, v24
    v_fmac_f32 v12, v36, v24
    v_fmac_f32 v13, v37, v24
    v_fmac_f32 v14, v38, v24
    v_fmac_f32 v15, v39, v24
    v_fmac_f32 v16, v40, v24
    v_fmac_f32 v17, v41, v24
    v_fmac_f32 v18, v42, v24
    v_fmac_f32 v19, v43, v24
    v_fmac_f32 v20, v44, v24
    v_fmac_f32 v21, v45, v24
    v_fmac_f32 v22, v46, v24
    v_fmac_f32 v23, v47, v24
    v_mul_f32 v32, v8, v8
    v_mul_f32 v33, v9, v9
    v_mul_f32 v34, v10, v10
    v_mul_f32 v35, v11, v11
    v_mul_f32 v36, v12, v12
    v_mul_f32 v37, v13, v13
    v_mul_f32 v38, v14, v14
    v_mul_f32 v39, v15, v15
    v_mul_f32 v40, v16, v16
    v_mul_f32 v41, v17, v17
    v_mul_f32 v42, v18, v18
    v_mul_f32 v43, v19, v19
    v_mul_f32 v44, v20, v20
    v_mul_f32 v45, v21, v21
    v_mul_f32 v46, v22, v22
    v_mul_f32 v47, v23, v23
    v_fma_f32 v32, v32, v26, v25
    v_fma_f32 v33, v33, v26, v25
    v_fma_f32 v34, v34, v26, v25
    v_fma_f32 v35, v35, v26, v25
    v_fma_f32 v36, v36, v26, v25
    v_fma_f32 v37, v37, v26, v25
    v_fma_f32 v38, v38, v26, v25
    v_fma_f32 v39, v39, v26, v25
    v_fma_f32 v40, v40, v26, v25
    v_fma_f32 v41, v41, v26, v25
    v_fma_f32 v42, v42, v26, v25
    v_fma_f32 v43, v43, v26, v25
    v_fma_f32 v44, v44, v26, v25
    v_fma_f32 v45, v45, v26, v25
    v_fma_f32 v46, v46, v26, v25
    v_fma_f32 v47, v47, v26, v25
    v_mul_f32 v32, v32, v8
    v_mul_f32 v33, v33, v9
    v_mul_f32 v34, v34, v10
    v_mul_f32 v35, v35, v11
    v_mul_f32 v36, v36, v12
    v_mul_f32 v37, v37, v13
    v_mul_f32 v38, v38, v14
    v_mul_f32 v39, v39, v15
    v_mul_f32 v40, v40, v16
    v_mul_f32 v41, v41, v17
    v_mul_f32 v42, v42, v18
    v_mul_f32 v43, v43, v19
    v_mul_f32 v44, v44, v20
    v_mul_f32 v45, v45, v21
    v_mul_f32 v46, v46, v22
    v_mul_f32 v47, v47, v23
    v_exp_f32 v32, v32
    v_exp_f32 v33, v33
    v_exp_f32 v34, v34
    v_exp_f32 v35, v35
    v_exp_f32 v36, v36
    v_exp_f32 v37, v37
    v_exp_f32 v38, v38
    v_exp_f32 v39, v39
    v_exp_f32 v40, v40
    v_exp_f32 v41, v41
    v_exp_f32 v42, v42
    v_exp_f32 v43, v43
    v_exp_f32 v44, v44
    v_exp_f32 v45, v45
    v_exp_f32 v46, v46
    v_exp_f32 v47, v47
    v_fma_f32 v32, v32, v27, v27
    v_fma_f32 v33, v33, v27, v27
    v_fma_f32 v34, v34, v27, v27
    v_fma_f32 v35, v35, v27, v27
    v_fma_f32 v36, v36, v27, v27
    v_fma_f32 v37, v37, v27, v27
    v_fma_f32 v38, v38, v27, v27
    v_fma_f32 v39, v39, v27, v27
    v_fma_f32 v40, v40, v27, v27
    v_fma_f32 v41, v41, v27, v27
    v_fma_f32 v42, v42, v27, v27
    v_fma_f32 v43, v43, v27, v27
    v_fma_f32 v44, v44, v27, v27
    v_fma_f32 v45, v45, v27, v27
    v_fma_f32 v46, v46, v27, v27
    v_fma_f32 v47, v47, v27, v27
    v_rcp_f32 v32, v32
    v_rcp_f32 v33, v33
    v_rcp_f32 v34, v34
    v_rcp_f32 v35, v35
    v_rcp_f32 v36, v36
    v_rcp_f32 v37, v37
    v_rcp_f32 v38, v38
    v_rcp_f32 v39, v39
    v_rcp_f32 v40, v40
    v_rcp_f32 v41, v41
    v_rcp_f32 v42, v42
    v_rcp_f32 v43, v43
    v_rcp_f32 v44, v44
    v_rcp_f32 v45, v45
    v_rcp_f32 v46, v46
    v_rcp_f32 v47, v47
    v_mul_f32 v8, v8, v32
    v_mul_f32 v9, v9, v33
    v_mul_f32 v10, v10, v34
    v_mul_f32 v11, v11, v35
    v_mul_f32 v12, v12, v36
    v_mul_f32 v13, v13, v37
    v_mul_f32 v14, v14, v38
    v_mul_f32 v15, v15, v39
    v_mul_f32 v16, v16, v40
    v_mul_f32 v17, v17, v41
    v_mul_f32 v18, v18, v42
    v_mul_f32 v19, v19, v43
    v_mul_f32 v20, v20, v44
    v_mul_f32 v21, v21, v45
    v_mul_f32 v22, v22, v46
    v_mul_f32 v23, v23, v47
    v_cvt_pk_bf16_f32 v40, v8, v9
    v_cvt_pk_bf16_f32 v44, v16, v17
    v_or_b32_sdwa v40, v8, 1 dst_sel:WORD_0 dst_unused:UNUSED_PRESERVE src0_sel:WORD_1 src1_sel:DWORD
    v_or_b32_sdwa v44, v16, 1 dst_sel:WORD_0 dst_unused:UNUSED_PRESERVE src0_sel:WORD_1 src1_sel:DWORD
    v_cvt_pk_bf16_f32 v41, v10, v11
    v_cvt_pk_bf16_f32 v42, v12, v13
    v_cvt_pk_bf16_f32 v43, v14, v15
    v_cvt_pk_bf16_f32 v45, v18, v19
    v_cvt_pk_bf16_f32 v46, v20, v21
    v_cvt_pk_bf16_f32 v47, v22, v23
    buffer_store_dwordx4 v[40:43], v1, s[8:11], s56 offen sc1
    buffer_store_dwordx4 v[44:47], v1, s[8:11], s56 offen offset:1024 sc1
    s_barrier
    s_add_u32 s42, s62, 0
    buffer_load_dwordx4 v[136:139], v1, s[8:11], s42 offen offset:2048 sc1
    buffer_load_dwordx4 v[140:143], v1, s[8:11], s42 offen offset:3072 sc1
    s_add_u32 s42, s50, 0
    buffer_load_dwordx4 v[144:147], v1, s[8:11], s42 offen offset:0 sc1
    buffer_load_dwordx4 v[148:151], v1, s[8:11], s42 offen offset:1024 sc1
    buffer_load_dwordx4 v[152:155], v1, s[8:11], s42 offen offset:2048 sc1
    buffer_load_dwordx4 v[156:159], v1, s[8:11], s42 offen offset:3072 sc1
    s_add_u32 s42, s50, 4096
    buffer_load_dwordx4 v[160:163], v1, s[8:11], s42 offen offset:0 sc1
    buffer_load_dwordx4 v[164:167], v1, s[8:11], s42 offen offset:1024 sc1
    buffer_load_dwordx4 v[168:171], v1, s[8:11], s42 offen offset:2048 sc1
    buffer_load_dwordx4 v[172:175], v1, s[8:11], s42 offen offset:3072 sc1
    s_mul_i32 s42, s3, 8448
    s_add_u32 s42, s42, 0
    v_lshl_add_u32 v6, v4, 4, v1
    v_add_u32 v6, s42, v6
    s_mul_i32 s42, s31, 4224
    v_add_u32 v5, s42, v6
    s_sub_u32 s42, 4224, s42
    v_add_u32 v6, s42, v6
    v_bfe_u32 v0, v1, 8, 1
    v_lshl_add_u32 v0, v0, 4, v4
    s_lshl_b32 s42, s3, 1
    v_add_u32 v0, s42, v0
    v_and_b32 v2, 15, v3
    v_mul_u32_u24 v7, 528, v2
    v_lshl_add_u32 v7, v0, 4, v7
    v_add_u32 v7, 0, v7
    v_lshlrev_b32 v0, 10, v0
    v_lshl_add_u32 v0, v2, 3, v0
    s_lshl_b32 s53, s28, 16
    s_lshl_b32 s42, s30, 7
    s_add_u32 s53, s53, s42
    s_add_u32 s54, s53, 0x8000
    v_add_u32 v3, 94208, v6
    s_setprio 1
    s_waitcnt vmcnt(9)
    v_mfma_f32_32x32x16_bf16 v[240:255], v[52:55], v[136:139], 0
    v_mfma_f32_32x32x16_bf16 v[224:239], v[48:51], v[136:139], 0
    v_mov_b32 v2, v136
    s_waitcnt vmcnt(8)
    v_mfma_f32_32x32x16_bf16 v[240:255], v[60:63], v[140:143], v[240:255]
    s_add_u32 s42, s62, 88064
    buffer_load_dwordx4 v[184:187], v1, s[8:11], s42 offen offset:2048 sc1
    v_mfma_f32_32x32x16_bf16 v[224:239], v[56:59], v[140:143], v[224:239]
    v_and_b32 v2, v2, v140
    s_waitcnt vmcnt(8)
    v_mfma_f32_32x32x16_bf16 v[240:255], v[68:71], v[144:147], v[240:255]
    v_mfma_f32_32x32x16_bf16 v[224:239], v[64:67], v[144:147], v[224:239]
    v_and_b32 v2, v2, v144
    s_waitcnt vmcnt(7)
    v_mfma_f32_32x32x16_bf16 v[240:255], v[76:79], v[148:151], v[240:255]
    s_add_u32 s42, s62, 88064
    buffer_load_dwordx4 v[188:191], v1, s[8:11], s42 offen offset:3072 sc1
    v_mfma_f32_32x32x16_bf16 v[224:239], v[72:75], v[148:151], v[224:239]
    v_and_b32 v2, v2, v148
    s_waitcnt vmcnt(7)
    v_mfma_f32_32x32x16_bf16 v[240:255], v[84:87], v[152:155], v[240:255]
    v_mfma_f32_32x32x16_bf16 v[224:239], v[80:83], v[152:155], v[224:239]
    v_and_b32 v2, v2, v152
    s_waitcnt vmcnt(6)
    v_mfma_f32_32x32x16_bf16 v[240:255], v[92:95], v[156:159], v[240:255]
    s_add_u32 s42, s50, 88064
    buffer_load_dwordx4 v[192:195], v1, s[8:11], s42 offen offset:0 sc1
    v_mfma_f32_32x32x16_bf16 v[224:239], v[88:91], v[156:159], v[224:239]
    v_and_b32 v2, v2, v156
    s_waitcnt vmcnt(6)
    v_mfma_f32_32x32x16_bf16 v[240:255], v[100:103], v[160:163], v[240:255]
    v_mfma_f32_32x32x16_bf16 v[224:239], v[96:99], v[160:163], v[224:239]
    v_and_b32 v2, v2, v160
    s_waitcnt vmcnt(5)
    v_mfma_f32_32x32x16_bf16 v[240:255], v[108:111], v[164:167], v[240:255]
    s_add_u32 s42, s50, 88064
    buffer_load_dwordx4 v[196:199], v1, s[8:11], s42 offen offset:1024 sc1
    v_mfma_f32_32x32x16_bf16 v[224:239], v[104:107], v[164:167], v[224:239]
    v_and_b32 v2, v2, v164
    s_waitcnt vmcnt(5)
    v_mfma_f32_32x32x16_bf16 v[240:255], v[116:119], v[168:171], v[240:255]
    v_mfma_f32_32x32x16_bf16 v[224:239], v[112:115], v[168:171], v[224:239]
    v_and_b32 v2, v2, v168
    s_waitcnt vmcnt(4)
    v_mfma_f32_32x32x16_bf16 v[240:255], v[124:127], v[172:175], v[240:255]
    s_add_u32 s42, s50, 88064
    buffer_load_dwordx4 v[200:203], v1, s[8:11], s42 offen offset:2048 sc1
    v_mfma_f32_32x32x16_bf16 v[224:239], v[120:123], v[172:175], v[224:239]
    v_and_b32 v2, v2, v172
W6_chk:
    v_and_b32 v2, 1, v2
    v_cmp_ne_u32 vcc, 1, v2
    s_cbranch_vccz W6_ok
    s_cmp_eq_u32 s34, 0
    s_cbranch_scc1 W6_ok
    s_sub_u32 s34, s34, 1
    s_mov_b32 s47, 1
    s_sleep 2
    s_and_b32 s98, s34, 63
    s_cbranch_scc1 W6_again
    v_mov_b32 v2, s34
    buffer_store_dword v2, off, s[8:11], s96 sc1
    s_branch W6_again
W6_ok:
    s_waitcnt vmcnt(4)
    v_mfma_f32_32x32x16_bf16 v[160:175], v[52:55], v[184:187], 0
    s_add_u32 s42, s50, 88064
    buffer_load_dwordx4 v[204:207], v1, s[8:11], s42 offen offset:3072 sc1
    v_mfma_f32_32x32x16_bf16 v[144:159], v[48:51], v[184:187], 0
    v_mov_b32 v2, v184
    s_waitcnt vmcnt(4)
    v_mfma_f32_32x32x16_bf16 v[160:175], v[60:63], v[188:191], v[160:175]
    s_add_u32 s42, s50, 92160
    buffer_load_dwordx4 v[208:211], v1, s[8:11], s42 offen offset:0 sc1
    v_mfma_f32_32x32x16_bf16 v[144:159], v[56:59], v[188:191], v[144:159]
    v_and_b32 v2, v2, v188
    ds_write_b128 v6, v[240:243] offset:0
    s_waitcnt vmcnt(4)
    v_mfma_f32_32x32x16_bf16 v[160:175], v[68:71], v[192:195], v[160:175]
    s_add_u32 s42, s50, 92160
    buffer_load_dwordx4 v[212:215], v1, s[8:11], s42 offen offset:1024 sc1
    ds_write_b128 v6, v[244:247] offset:1056
    v_mfma_f32_32x32x16_bf16 v[144:159], v[64:67], v[192:195], v[144:159]
    v_and_b32 v2, v2, v192
    ds_write_b128 v6, v[248:251] offset:2112
    s_waitcnt vmcnt(4)
    v_mfma_f32_32x32x16_bf16 v[160:175], v[76:79], v[196:199], v[160:175]
    s_add_u32 s42, s50, 92160
    buffer_load_dwordx4 v[216:219], v1, s[8:11], s42 offen offset:2048 sc1
    ds_write_b128 v6, v[252:255] offset:3168
    v_mfma_f32_32x32x16_bf16 v[144:159], v[72:75], v[196:199], v[144:159]
    v_and_b32 v2, v2, v196
    ds_write_b128 v5, v[224:227] offset:0
    s_waitcnt vmcnt(4)
    v_mfma_f32_32x32x16_bf16 v[160:175], v[84:87], v[200:203], v[160:175]
    s_add_u32 s42, s50, 92160
    buffer_load_dwordx4 v[220:223], v1, s[8:11], s42 offen offset:3072 sc1
    ds_write_b128 v5, v[228:231] offset:1056
    v_mfma_f32_32x32x16_bf16 v[144:159], v[80:83], v[200:203], v[144:159]
    v_and_b32 v2, v2, v200
    ds_write_b128 v5, v[232:235] offset:2112
    s_waitcnt vmcnt(4)
    v_mfma_f32_32x32x16_bf16 v[160:175], v[92:95], v[204:207], v[160:175]
    ds_write_b128 v5, v[236:239] offset:3168
    v_mfma_f32_32x32x16_bf16 v[144:159], v[88:91], v[204:207], v[144:159]
    v_and_b32 v2, v2, v204
    s_waitcnt vmcnt(3)
    v_mfma_f32_32x32x16_bf16 v[160:175], v[100:103], v[208:211], v[160:175]
    v_and_b32 v2, v2, v208
    s_waitcnt vmcnt(2)
    v_mfma_f32_32x32x16_bf16 v[160:175], v[108:111], v[212:215], v[160:175]
    v_and_b32 v2, v2, v212
    s_waitcnt vmcnt(1)
    v_mfma_f32_32x32x16_bf16 v[160:175], v[116:119], v[216:219], v[160:175]
    v_and_b32 v2, v2, v216
    s_waitcnt vmcnt(0)
    v_mfma_f32_32x32x16_bf16 v[160:175], v[124:127], v[220:223], v[160:175]
    v_and_b32 v2, v2, v220
    v_mfma_f32_32x32x16_bf16 v[144:159], v[96:99], v[208:211], v[144:159]
    v_mfma_f32_32x32x16_bf16 v[144:159], v[104:107], v[212:215], v[144:159]
    v_mfma_f32_32x32x16_bf16 v[144:159], v[112:115], v[216:219], v[144:159]
    s_nop 7
    ds_write_b128 v3, v[160:163] offset:0
    ds_write_b128 v3, v[164:167] offset:1056
    v_mfma_f32_32x32x16_bf16 v[144:159], v[120:123], v[220:223], v[144:159]
    ds_write_b128 v3, v[168:171] offset:2112
    ds_write_b128 v3, v[172:175] offset:3168
    v_and_b32 v2, 1, v2
    v_cmp_ne_u32 vcc, 1, v2
    s_cbranch_vccz W7_ok
    s_cmp_eq_u32 s34, 0
    s_cbranch_scc1 W7_ok
    s_sub_u32 s34, s34, 1
    s_mov_b32 s47, 1
    s_sleep 2
    s_and_b32 s98, s34, 63
    s_cbranch_scc1 W8_again
    v_mov_b32 v2, s34
    buffer_store_dword v2, off, s[8:11], s96 sc1
    s_branch W8_again
W7_ok:
W4_join:
    v_add_u32 v5, 94208, v5
    s_nop 5
    ds_write_b128 v5, v[144:147] offset:0
    ds_write_b128 v5, v[148:151] offset:1056
    ds_write_b128 v5, v[152:155] offset:2112
    ds_write_b128 v5, v[156:159] offset:3168
    v_add_u32 v6, 94208, v7
    s_waitcnt lgkmcnt(0)
    s_barrier
    ds_read_b128 v[128:131], v7 offset:0
    ds_read_b128 v[132:135], v7 offset:8448
    ds_read_b128 v[136:139], v7 offset:16896
    ds_read_b128 v[140:143], v7 offset:25344
    ds_read_b128 v[144:147], v7 offset:33792
    ds_read_b128 v[148:151], v7 offset:42240
    ds_read_b128 v[152:155], v7 offset:50688
    ds_read_b128 v[156:159], v7 offset:59136
    ds_read_b128 v[160:163], v6 offset:0
    ds_read_b128 v[164:167], v6 offset:8448
    ds_read_b128 v[168:171], v6 offset:16896
    ds_read_b128 v[172:175], v6 offset:25344
    ds_read_b128 v[176:179], v6 offset:33792
    ds_read_b128 v[180:183], v6 offset:42240
    ds_read_b128 v[184:187], v6 offset:50688
    ds_read_b128 v[188:191], v6 offset:59136
    s_waitcnt lgkmcnt(14)
    v_pk_add_f32 v[132:133], v[132:133], v[128:129]
    v_pk_add_f32 v[134:135], v[134:135], v[130:131]
    s_waitcnt lgkmcnt(12)
    v_pk_add_f32 v[140:141], v[140:141], v[136:137]
    v_pk_add_f32 v[142:143], v[142:143], v[138:139]
    v_pk_add_f32 v[132:133], v[132:133], v[140:141]
    v_pk_add_f32 v[134:135], v[134:135], v[142:143]
    s_waitcnt lgkmcnt(10)
    v_pk_add_f32 v[148:149], v[148:149], v[144:145]
    v_pk_add_f32 v[150:151], v[150:151], v[146:147]
    v_pk_add_f32 v[132:133], v[132:133], v[148:149]
    v_pk_add_f32 v[134:135], v[134:135], v[150:151]
    s_waitcnt lgkmcnt(8)
    v_pk_add_f32 v[156:157], v[156:157], v[152:153]
    v_pk_add_f32 v[158:159], v[158:159], v[154:155]
    v_pk_add_f32 v[132:133], v[132:133], v[156:157]
    v_pk_add_f32 v[134:135], v[134:135], v[158:159]
    v_cvt_pk_bf16_f32 v128, v132, v133
    v_cvt_pk_bf16_f32 v129, v134, v135
    buffer_store_dwordx2 v[128:129], v0, s[4:7], s53 offen
    s_waitcnt lgkmcnt(6)
    v_pk_add_f32 v[164:165], v[164:165], v[160:161]
    v_pk_add_f32 v[166:167], v[166:167], v[162:163]
    s_waitcnt lgkmcnt(4)
    v_pk_add_f32 v[172:173], v[172:173], v[168:169]
    v_pk_add_f32 v[174:175], v[174:175], v[170:171]
    v_pk_add_f32 v[164:165], v[164:165], v[172:173]
    v_pk_add_f32 v[166:167], v[166:167], v[174:175]
    s_waitcnt lgkmcnt(2)
    v_pk_add_f32 v[180:181], v[180:181], v[176:177]
    v_pk_add_f32 v[182:183], v[182:183], v[178:179]
    v_pk_add_f32 v[164:165], v[164:165], v[180:181]
    v_pk_add_f32 v[166:167], v[166:167], v[182:183]
    s_waitcnt lgkmcnt(0)
    v_pk_add_f32 v[188:189], v[188:189], v[184:185]
    v_pk_add_f32 v[190:191], v[190:191], v[186:187]
    v_pk_add_f32 v[164:165], v[164:165], v[188:189]
    v_pk_add_f32 v[166:167], v[166:167], v[190:191]
    v_cvt_pk_bf16_f32 v160, v164, v165
    v_cvt_pk_bf16_f32 v161, v166, v167
    buffer_store_dwordx2 v[160:161], v0, s[4:7], s54 offen
M_done:
    s_endpgm
B2_again:
    buffer_load_dwordx4 v[8:11], v16, s[8:11], s43 offen offset:0 sc1
    buffer_load_dwordx4 v[12:15], v16, s[8:11], s43 offen offset:2048 sc1
    s_waitcnt vmcnt(0)
    s_branch B2_body
W6_again:
    s_add_u32 s42, s62, 0
    buffer_load_dwordx4 v[136:139], v1, s[8:11], s42 offen offset:2048 sc1
    buffer_load_dwordx4 v[140:143], v1, s[8:11], s42 offen offset:3072 sc1
    s_add_u32 s42, s50, 0
    buffer_load_dwordx4 v[144:147], v1, s[8:11], s42 offen offset:0 sc1
    buffer_load_dwordx4 v[148:151], v1, s[8:11], s42 offen offset:1024 sc1
    buffer_load_dwordx4 v[152:155], v1, s[8:11], s42 offen offset:2048 sc1
    buffer_load_dwordx4 v[156:159], v1, s[8:11], s42 offen offset:3072 sc1
    s_add_u32 s42, s50, 4096
    buffer_load_dwordx4 v[160:163], v1, s[8:11], s42 offen offset:0 sc1
    buffer_load_dwordx4 v[164:167], v1, s[8:11], s42 offen offset:1024 sc1
    buffer_load_dwordx4 v[168:171], v1, s[8:11], s42 offen offset:2048 sc1
    buffer_load_dwordx4 v[172:175], v1, s[8:11], s42 offen offset:3072 sc1
    s_waitcnt vmcnt(0)
    v_mfma_f32_32x32x16_bf16 v[240:255], v[52:55], v[136:139], 0
    v_mfma_f32_32x32x16_bf16 v[224:239], v[48:51], v[136:139], 0
    v_mov_b32 v2, v136
    v_mfma_f32_32x32x16_bf16 v[240:255], v[60:63], v[140:143], v[240:255]
    v_mfma_f32_32x32x16_bf16 v[224:239], v[56:59], v[140:143], v[224:239]
    v_and_b32 v2, v2, v140
    v_mfma_f32_32x32x16_bf16 v[240:255], v[68:71], v[144:147], v[240:255]
    v_mfma_f32_32x32x16_bf16 v[224:239], v[64:67], v[144:147], v[224:239]
    v_and_b32 v2, v2, v144
    v_mfma_f32_32x32x16_bf16 v[240:255], v[76:79], v[148:151], v[240:255]
    v_mfma_f32_32x32x16_bf16 v[224:239], v[72:75], v[148:151], v[224:239]
    v_and_b32 v2, v2, v148
    v_mfma_f32_32x32x16_bf16 v[240:255], v[84:87], v[152:155], v[240:255]
    v_mfma_f32_32x32x16_bf16 v[224:239], v[80:83], v[152:155], v[224:239]
    v_and_b32 v2, v2, v152
    v_mfma_f32_32x32x16_bf16 v[240:255], v[92:95], v[156:159], v[240:255]
    v_mfma_f32_32x32x16_bf16 v[224:239], v[88:91], v[156:159], v[224:239]
    v_and_b32 v2, v2, v156
    v_mfma_f32_32x32x16_bf16 v[240:255], v[100:103], v[160:163], v[240:255]
    v_mfma_f32_32x32x16_bf16 v[224:239], v[96:99], v[160:163], v[224:239]
    v_and_b32 v2, v2, v160
    v_mfma_f32_32x32x16_bf16 v[240:255], v[108:111], v[164:167], v[240:255]
    v_mfma_f32_32x32x16_bf16 v[224:239], v[104:107], v[164:167], v[224:239]
    v_and_b32 v2, v2, v164
    v_mfma_f32_32x32x16_bf16 v[240:255], v[116:119], v[168:171], v[240:255]
    v_mfma_f32_32x32x16_bf16 v[224:239], v[112:115], v[168:171], v[224:239]
    v_and_b32 v2, v2, v168
    v_mfma_f32_32x32x16_bf16 v[240:255], v[124:127], v[172:175], v[240:255]
    v_mfma_f32_32x32x16_bf16 v[224:239], v[120:123], v[172:175], v[224:239]
    v_and_b32 v2, v2, v172
    s_branch W6_chk
AT_slow:
    s_add_u32 s38, s36, 0x10000
    s_mov_b32 s29, 64
    v_mov_b32 v92, 0xff7fffff
    s_waitcnt lgkmcnt(0)
AS_max:
    buffer_load_dwordx4 v[64:67], v1, s[8:11], s38 offen
    s_add_u32 s38, s38, 1024
    s_waitcnt vmcnt(0)
    v_mfma_f32_32x32x16_bf16 v[32:47], v[64:67], v[12:15], 0
    s_nop 11
    v_max3_f32 v92, v32, v33, v92
    v_max3_f32 v92, v34, v35, v92
    v_max3_f32 v92, v36, v37, v92
    v_max3_f32 v92, v38, v39, v92
    v_max3_f32 v92, v40, v41, v92
    v_max3_f32 v92, v42, v43, v92
    v_max3_f32 v92, v44, v45, v92
    v_max3_f32 v92, v46, v47, v92
    s_sub_u32 s29, s29, 1
    s_cmp_lg_u32 s29, 0
    s_cbranch_scc1 AS_max
    v_mov_b32 v93, v92
    s_nop 1
    v_permlane32_swap_b32 v92, v93
    v_max_f32 v92, v92, v93
    v_mov_b32 v16, 0
    v_mov_b32 v17, 0
    v_mov_b32 v18, 0
    v_mov_b32 v19, 0
    v_mov_b32 v20, 0
    v_mov_b32 v21, 0
    v_mov_b32 v22, 0
    v_mov_b32 v23, 0
    v_mov_b32 v24, 0
    v_mov_b32 v25, 0
    v_mov_b32 v26, 0
    v_mov_b32 v27, 0
    v_mov_b32 v28, 0
    v_mov_b32 v29, 0
    v_mov_b32 v30, 0
    v_mov_b32 v31, 0
    s_add_u32 s38, s36, 0x10000
    s_add_u32 s39, s36, 0x34000
    s_mov_b32 s29, 64
    v_and_b32 v6, 15, v3
    v_lshlrev_b32 v6, 4, v6
    v_lshl_add_u32 v6, v4, 8, v6
AS_pv:
    buffer_load_dwordx4 v[64:67], v1, s[8:11], s38 offen
    s_mov_b64 exec, s[32:33]
    buffer_load_dwordx4 v[72:75], v6, s[8:11], s39 offen
    buffer_load_dwordx4 v[76:79], v6, s[8:11], s39 offen offset:512
    s_mov_b64 exec, -1
    s_add_u32 s38, s38, 1024
    s_add_u32 s39, s39, 1024
    s_waitcnt vmcnt(0)
    v_mfma_f32_32x32x16_bf16 v[32:47], v[64:67], v[12:15], 0
    s_nop 11
    v_sub_f32 v32, v32, v92
    v_sub_f32 v33, v33, v92
    v_sub_f32 v34, v34, v92
    v_sub_f32 v35, v35, v92
    v_sub_f32 v36, v36, v92
    v_sub_f32 v37, v37, v92
    v_sub_f32 v38, v38, v92
    v_sub_f32 v39, v39, v92
    v_sub_f32 v40, v40, v92
    v_sub_f32 v41, v41, v92
    v_sub_f32 v42, v42, v92
    v_sub_f32 v43, v43, v92
    v_sub_f32 v44, v44, v92
    v_sub_f32 v45, v45, v92
    v_sub_f32 v46, v46, v92
    v_sub_f32 v47, v47, v92
    v_exp_f32 v32, v32
    v_exp_f32 v33, v33
    v_exp_f32 v34, v34
    v_exp_f32 v35, v35
    v_exp_f32 v36, v36
    v_exp_f32 v37, v37
    v_exp_f32 v38, v38
    v_exp_f32 v39, v39
    v_exp_f32 v40, v40
    v_exp_f32 v41, v41
    v_exp_f32 v42, v42
    v_exp_f32 v43, v43
    v_exp_f32 v44, v44
    v_exp_f32 v45, v45
    v_exp_f32 v46, v46
    v_exp_f32 v47, v47
    v_smfmac_f32_32x32x32_bf16 v[16:31], v[72:75], v[32:39], v7
    s_nop 0
    v_smfmac_f32_32x32x32_bf16 v[16:31], v[76:79], v[40:47], v7
    s_sub_u32 s29, s29, 1
    s_cmp_lg_u32 s29, 0
    s_cbranch_scc1 AS_pv
    s_branch AT_fin
.section .rodata,"a"
.p2align 6
.amdhsa_kernel sequential_preLN__mha_block__mixer_s_mlp__prompt_kernel
  .amdhsa_next_free_vgpr 256
  .amdhsa_next_free_sgpr 100
  .amdhsa_accum_offset 256
  .amdhsa_group_segment_fixed_size 0
  .amdhsa_kernarg_size 88
  .amdhsa_user_sgpr_count 2
  .amdhsa_user_sgpr_kernarg_segment_ptr 1
  .amdhsa_system_sgpr_workgroup_id_x 1
.end_amdhsa_kernel
```
